```python
import torch

def _softmax(x, axis=-1):
    return torch.softmax(x, dim=axis)
def _gelu(x):
    return torch.nn.functional.gelu(x, approximate="tanh")
def _silu(x):
    return torch.nn.functional.silu(x)
def _sigmoid(x):
    return torch.sigmoid(x)
def _layernorm(x, axis=-1, eps=1e-5):
    m = x.mean(dim=axis, keepdim=True)
    v = x.var(dim=axis, keepdim=True, unbiased=False)
    return (x - m) / torch.sqrt(v + eps)
def _scatter_add(tgt, idx, src, axis=0):
    return tgt.clone().index_add_(axis, idx, src)
def _segment_sum(src, seg, n):
    out = torch.zeros((n,) + src.shape[1:], dtype=src.dtype)
    return out.index_add_(0, seg, src)
def _pad(x, pw):
    flat = tuple(v for pair in reversed(pw) for v in pair)
    return torch.nn.functional.pad(x, flat)

kernel_name = 'parallel_sum__sliding_block__moe_arch_mod__prompt'

def setup_inputs():

    _w = (lambda a: (lambda t: t.to(torch.bfloat16) if t.is_floating_point() else t)(torch.as_tensor(a)))
    def _A_setup():
        B, S, D = 1, 2048, 512
        return {
            "x": _w((lambda *s: torch.randn(*s, dtype=torch.bfloat16) * 0.05)(B, S, D)),
            "wqkv": _w((lambda *s: torch.randn(*s, dtype=torch.bfloat16) * 0.05)(D, 3 * D)),
            "wo": _w((lambda *s: torch.randn(*s, dtype=torch.bfloat16) * 0.1)(D, D)),
        }
    _A_in = _A_setup()

    def _B_setup():
        B, S, D, F, C = 1, 2048, 512, 1792, 8
        return {
            "x": _w((lambda *s: torch.randn(*s, dtype=torch.bfloat16) * 0.05)(B, S, D)),
            "w_r": _w((lambda *s: torch.randn(*s, dtype=torch.bfloat16) * 0.05)(D)),
            "w_gate": _w((lambda *s: torch.randn(*s, dtype=torch.bfloat16) * 0.05)(D, F)),
            "w_up": _w((lambda *s: torch.randn(*s, dtype=torch.bfloat16) * 0.05)(D, F)),
            "w_down": _w((lambda *s: torch.randn(*s, dtype=torch.bfloat16) * 0.05)(F, D)),
        }
    _B_in = _B_setup()

    return {
        "A_x": _A_in["x"],
        "A_wqkv": _A_in["wqkv"],
        "A_wo": _A_in["wo"],
        "B_x": _B_in["x"],
        "B_w_r": _B_in["w_r"],
        "B_w_gate": _B_in["w_gate"],
        "B_w_up": _B_in["w_up"],
        "B_w_down": _B_in["w_down"],
    }

def reference(A_x, A_wqkv, A_wo, B_x, B_w_r, B_w_gate, B_w_up, B_w_down):
    def _A_ref(x, wqkv, wo):
        B, S, D = x.shape
        H = 32; Dh = D // H; W = 256
        qkv = (lambda x, *d: x.permute(*d))((x @ wqkv).reshape(B, S, 3, H, Dh), 2, 0, 3, 1, 4)
        q, k, v = qkv[0], qkv[1], qkv[2]
        scores = torch.einsum("bhqd,bhkd->bhqk", q, k) * (Dh ** -0.5)
        idx = torch.arange(S)
        mask = (idx[:, None] - idx[None, :] >= 0) & (idx[:, None] - idx[None, :] < W)
        scores = torch.where(mask[None, None], scores, -1e9)
        p = _softmax(scores, axis=-1)
        o = torch.einsum("bhqk,bhkd->bhqd", p, v)
        return (lambda x, *d: x.permute(*d))(o, 0, 2, 1, 3).reshape(B, S, D) @ wo

    def _B_ref(x, w_r, w_gate, w_up, w_down):
        B, S, D = x.shape
        C = 8
        r = x @ w_r
        idx = torch.argsort(-r, axis=-1)[:, :C]
        idx_e = (lambda x, n, axis: torch.repeat_interleave(x, n, dim=axis))(idx.reshape(B, C, 1), D, axis=2)
        x_sel = (lambda x, i, axis: torch.take_along_dim(x, i, dim=axis))(x, idx_e, axis=1)
        g = _silu(x_sel @ w_gate)
        u = x_sel @ w_up
        y = (g * u) @ w_down
        r_sel = _sigmoid((lambda x, i, axis: torch.take_along_dim(x, i, dim=axis))(r, idx, axis=1))
        y = y * r_sel.reshape(B, C, 1)
        b_off = (torch.arange(B) * S).reshape(B, 1)
        flat_idx = (idx + b_off).reshape(B * C)
        zero = (x * 0.0).reshape(B * S, D)
        upd = _scatter_add(zero, flat_idx, y.reshape(B * C, D), axis=0)
        return x + upd.reshape(B, S, D)

    x = A_x
    xn = _layernorm(x, axis=-1)
    return x + _A_ref(xn, A_wqkv, A_wo) + _B_ref(xn, B_w_r, B_w_gate, B_w_up, B_w_down)
```

```asm
; @launch kernel=k1_kernel grid=(256,1,1) block=(512,1,1) lds=132096
; @launch kernel=k2_kernel grid=(256,1,1) block=(1024,1,1) lds=163840
; @launch kernel=k3_kernel grid=(256,1,1) block=(768,1,1) lds=133120
.amdgcn_target "amdgcn-amd-amdhsa--gfx950"
.text
.globl k1_kernel
.p2align 8
.type k1_kernel,@function
k1_kernel:

s_cmp_ge_u32 s2, 256
s_cbranch_scc1 L_k1_end
s_load_dwordx4 s[4:7], s[0:1], 0
s_load_dwordx8 s[12:19], s[0:1], 32
s_load_dwordx4 s[20:23], s[0:1], 72
v_lshrrev_b32 v2, 6, v0
v_and_b32 v1, 63, v0
v_readfirstlane_b32 s3, v2
s_cmp_ge_u32 s2, 8
s_cbranch_scc1 L_k1_nocode
s_cmp_lt_u32 s3, 4
s_cbranch_scc1 L_k1_nocode
s_getpc_b64 s[40:41]
L_k1_anchor:
s_mov_b32 s42, L_code_end-L_k1_anchor
s_mov_b32 s43, 0x20000
s_sub_u32 s44, s3, 4
s_lshl_b32 s44, s44, 13
v_lshlrev_b32 v3, 7, v1
v_add_u32 v3, s44, v3
buffer_load_dword v191, v3, s[40:43], 0 offen
L_k1_nocode:
s_cmp_lt_u32 s2, 64
s_cbranch_scc1 L_k1_aux
s_sub_u32 s42, s2, 64
s_and_b32 s43, s42, 7
s_lshr_b32 s42, s42, 3
s_lshr_b32 s40, s43, 1
s_lshl_b32 s40, s40, 2
s_and_b32 s46, s42, 3
s_add_u32 s40, s40, s46
s_and_b32 s41, s43, 1
s_mul_i32 s41, s41, 6
s_lshr_b32 s42, s42, 2
s_add_u32 s41, s41, s42
s_cmp_ge_u32 s3, 4
s_cbranch_scc0 L_g_cons
s_sub_u32 s46, s3, 4
v_lshrrev_b32 v2, 3, v1
v_and_b32 v3, 7, v1
v_lshrrev_b32 v4, 1, v2
v_xor_b32 v3, v3, v4
v_xor_b32 v4, 4, v3
v_lshlrev_b32 v2, 10, v2
v_lshl_add_u32 v10, v3, 4, v2
v_lshl_add_u32 v11, v4, 4, v2
v_add_u32 v11, 0x2000, v11
v_lshrrev_b32 v2, 4, v1
v_bfe_u32 v3, v1, 2, 2
v_xor_b32 v3, v3, v2
v_and_b32 v4, 3, v1
v_lshl_add_u32 v3, v3, 2, v4
v_mul_u32_u24 v2, 0xc00, v2
v_lshl_add_u32 v12, v3, 4, v2
v_add_u32 v13, 12288, v12
v_add_u32 v14, 24576, v12
v_add_u32 v15, 36864, v12
s_lshl_b32 s47, s40, 17
s_lshl_b32 s42, s46, 15
s_add_u32 s47, s47, s42
s_mul_i32 s49, s46, 49152
s_lshl_b32 s42, s41, 8
s_add_u32 s49, s49, s42
s_lshl_b32 s50, s46, 12
s_mov_b32 s45, 0
s_waitcnt lgkmcnt(0)
s_mov_b32 s24, s4
s_mov_b32 s25, s5
s_mov_b32 s26, 0x200000
s_mov_b32 s27, 0x20000
s_mov_b32 s28, s6
s_mov_b32 s29, s7
s_mov_b32 s30, 0x180000
s_mov_b32 s31, 0x20000
s_mov_b32 s32, s22
s_mov_b32 s33, s23
s_mov_b32 s34, 0x900000
s_mov_b32 s35, 0x20000
s_mov_b32 s44, 0
L_g_lpro:
s_add_u32 s48, s47, 0x4000
s_add_u32 m0, s45, s50
s_nop 0
buffer_load_dwordx4 v10, s[24:27], s47 offen lds
s_add_u32 m0, m0, 1024
s_nop 0
buffer_load_dwordx4 v11, s[24:27], s47 offen lds
s_add_u32 m0, m0, 1024
s_nop 0
buffer_load_dwordx4 v10, s[24:27], s48 offen lds
s_add_u32 m0, m0, 1024
s_nop 0
buffer_load_dwordx4 v11, s[24:27], s48 offen lds
s_add_u32 m0, m0, 13312
s_nop 0
buffer_load_dwordx4 v12, s[28:31], s49 offen lds
s_add_u32 m0, m0, 1024
s_nop 0
buffer_load_dwordx4 v13, s[28:31], s49 offen lds
s_add_u32 m0, m0, 1024
s_nop 0
buffer_load_dwordx4 v14, s[28:31], s49 offen lds
s_add_u32 m0, m0, 1024
s_nop 0
buffer_load_dwordx4 v15, s[28:31], s49 offen lds
s_add_u32 s47, s47, 128
s_add_u32 s49, s49, 196608
s_add_u32 s45, s45, 0x8000
s_and_b32 s45, s45, 0x1ffff
s_add_u32 s44, s44, 1
s_cmp_lt_u32 s44, 2
s_cbranch_scc1 L_g_lpro
s_mov_b32 s44, 0
L_g_lloop:
s_waitcnt vmcnt(8)
s_barrier
s_add_u32 s48, s47, 0x4000
s_add_u32 m0, s45, s50
s_nop 0
buffer_load_dwordx4 v10, s[24:27], s47 offen lds
s_add_u32 m0, m0, 1024
s_nop 0
buffer_load_dwordx4 v11, s[24:27], s47 offen lds
s_add_u32 m0, m0, 1024
s_nop 0
buffer_load_dwordx4 v10, s[24:27], s48 offen lds
s_add_u32 m0, m0, 1024
s_nop 0
buffer_load_dwordx4 v11, s[24:27], s48 offen lds
s_add_u32 m0, m0, 13312
s_nop 0
buffer_load_dwordx4 v12, s[28:31], s49 offen lds
s_add_u32 m0, m0, 1024
s_nop 0
buffer_load_dwordx4 v13, s[28:31], s49 offen lds
s_add_u32 m0, m0, 1024
s_nop 0
buffer_load_dwordx4 v14, s[28:31], s49 offen lds
s_add_u32 m0, m0, 1024
s_nop 0
buffer_load_dwordx4 v15, s[28:31], s49 offen lds
s_add_u32 s47, s47, 128
s_add_u32 s49, s49, 196608
s_add_u32 s45, s45, 0x8000
s_and_b32 s45, s45, 0x1ffff
s_add_u32 s44, s44, 1
s_cmp_lt_u32 s44, 4
s_cbranch_scc1 L_g_lloop
s_load_dwordx2 s[58:59], s[0:1], 16
s_sub_u32 s60, s2, 64
s_and_b32 s62, s60, 7
s_lshr_b32 s60, s60, 3
s_lshl_b32 s60, s60, 2
s_add_u32 s60, s60, s46
s_mul_i32 s61, s60, 2731
s_lshr_b32 s61, s61, 16
s_mul_i32 s63, s61, 24
s_sub_u32 s63, s60, s63
s_lshl_b32 s61, s61, 3
s_add_u32 s61, s61, s62
s_waitcnt lgkmcnt(0)
v_mul_u32_u24 v20, 0xe00, v1
v_lshlrev_b32 v22, 7, v1
s_mov_b32 s64, s14
s_mov_b32 s65, s15
s_mov_b32 s66, 1835008
s_mov_b32 s67, 0x20000
s_cmp_ge_u32 s63, 8
s_cselect_b32 s64, s16, s64
s_cselect_b32 s65, s17, s65
s_and_b32 s68, s63, 7
s_mul_i32 s69, s68, 229376
s_lshl_b32 s70, s61, 7
s_add_u32 s69, s69, s70
s_cmp_ge_u32 s63, 16
s_cbranch_scc0 L_g_pfa
s_mov_b32 s64, s18
s_mov_b32 s65, s19
s_lshl_b32 s69, s61, 16
s_lshl_b32 s70, s68, 13
s_add_u32 s69, s69, s70
v_mov_b32 v20, v22
L_g_pfa:
s_cmp_ge_u32 s61, 28
s_cbranch_scc0 L_g_pfb
s_mov_b32 s64, s58
s_mov_b32 s65, s59
s_mov_b32 s66, 524288
s_sub_u32 s69, s62, 4
s_lshl_b32 s69, s69, 4
s_and_b32 s70, s63, 15
s_add_u32 s69, s69, s70
s_lshl_b32 s69, s69, 13
v_mov_b32 v20, v22
L_g_pfb:
s_mov_b32 s61, s69
s_mov_b32 s36, s20
s_mov_b32 s37, s21
s_mov_b32 s38, 0x100
s_mov_b32 s39, 0x20000
v_mov_b32 v4, 0
s_lshl_b32 s42, s40, 11
s_add_u32 s51, s42, 0x800000
v_and_b32 v7, 31, v1
s_lshl_b32 s42, s46, 9
v_lshl_add_u32 v6, v7, 4, s42
s_lshl_b32 s42, s46, 7
s_add_u32 s42, s42, 131072
v_lshl_add_u32 v7, v7, 2, s42
s_waitcnt vmcnt(8)
s_barrier
buffer_load_dword v5, v4, s[36:39], 0 offen sc1
s_add_u32 s48, s47, 0x4000
s_add_u32 m0, s45, s50
s_nop 0
buffer_load_dwordx4 v10, s[24:27], s47 offen lds
s_add_u32 m0, m0, 1024
s_nop 0
buffer_load_dwordx4 v11, s[24:27], s47 offen lds
s_add_u32 m0, m0, 1024
s_nop 0
buffer_load_dwordx4 v10, s[24:27], s48 offen lds
s_add_u32 m0, m0, 1024
s_nop 0
buffer_load_dwordx4 v11, s[24:27], s48 offen lds
s_add_u32 m0, m0, 13312
s_nop 0
buffer_load_dwordx4 v12, s[28:31], s49 offen lds
s_add_u32 m0, m0, 1024
s_nop 0
buffer_load_dwordx4 v13, s[28:31], s49 offen lds
s_add_u32 m0, m0, 1024
s_nop 0
buffer_load_dwordx4 v14, s[28:31], s49 offen lds
s_add_u32 m0, m0, 1024
s_nop 0
buffer_load_dwordx4 v15, s[28:31], s49 offen lds
s_add_u32 s47, s47, 128
s_add_u32 s49, s49, 196608
s_add_u32 s45, s45, 0x8000
s_and_b32 s45, s45, 0x1ffff
s_waitcnt vmcnt(8)
s_barrier
buffer_load_dwordx4 v[16:19], v6, s[32:35], s51 offen sc1
s_add_u32 s48, s47, 0x4000
s_add_u32 m0, s45, s50
s_nop 0
buffer_load_dwordx4 v10, s[24:27], s47 offen lds
s_add_u32 m0, m0, 1024
s_nop 0
buffer_load_dwordx4 v11, s[24:27], s47 offen lds
s_add_u32 m0, m0, 1024
s_nop 0
buffer_load_dwordx4 v10, s[24:27], s48 offen lds
s_add_u32 m0, m0, 1024
s_nop 0
buffer_load_dwordx4 v11, s[24:27], s48 offen lds
s_add_u32 m0, m0, 13312
s_nop 0
buffer_load_dwordx4 v12, s[28:31], s49 offen lds
s_add_u32 m0, m0, 1024
s_nop 0
buffer_load_dwordx4 v13, s[28:31], s49 offen lds
s_add_u32 m0, m0, 1024
s_nop 0
buffer_load_dwordx4 v14, s[28:31], s49 offen lds
s_add_u32 m0, m0, 1024
s_nop 0
buffer_load_dwordx4 v15, s[28:31], s49 offen lds
s_add_u32 s47, s47, 128
s_add_u32 s49, s49, 196608
s_add_u32 s45, s45, 0x8000
s_and_b32 s45, s45, 0x1ffff
buffer_load_dword v21, v20, s[64:67], s61 offen
s_waitcnt vmcnt(9)
v_readfirstlane_b32 s52, v5
s_nop 3
s_cmp_lg_u32 s52, 0
s_cbranch_scc1 L_g_nonok
v_mov_b32 v4, 0
s_mov_b32 s98, 0
L_nonce_g:
buffer_load_dword v5, v4, s[36:39], 0 offen sc1
s_add_u32 s98, s98, 1
s_waitcnt vmcnt(0)
v_readfirstlane_b32 s52, v5
s_cmp_gt_u32 s98, 0x40000
s_cbranch_scc1 L_nonced_g
s_cmp_lg_u32 s52, 0
s_cbranch_scc1 L_nonced_g
s_sleep 4
s_branch L_nonce_g
L_nonced_g:
L_g_nonok:
s_mov_b32 s98, 0
L_g_rec:
v_cmp_ne_u32 vcc, s52, v19
s_cmp_gt_u32 s98, 0x40000
s_cbranch_scc1 L_g_recok
s_cmp_eq_u64 vcc, 0
s_cbranch_scc1 L_g_recok
s_sleep 4
buffer_load_dwordx4 v[16:19], v6, s[32:35], s51 offen sc1
s_add_u32 s98, s98, 1
s_waitcnt vmcnt(0)
s_branch L_g_rec
L_g_recok:
ds_write_b32 v7, v16
ds_write_b32 v7, v17 offset:512
s_barrier
s_waitcnt vmcnt(1) lgkmcnt(0)
s_barrier
s_endpgm
L_g_cons:
s_waitcnt lgkmcnt(0)
s_mov_b32 s32, s22
s_mov_b32 s33, s23
s_mov_b32 s34, 0x900000
s_mov_b32 s35, 0x20000
s_and_b32 s46, s3, 1
s_lshr_b32 s47, s3, 1
v_and_b32 v2, 31, v1
v_lshrrev_b32 v3, 5, v1
v_cmp_eq_u32 s[48:49], 1, v3
v_lshrrev_b32 v10, 1, v2
v_and_b32 v10, 7, v10
s_lshl_b32 s42, s46, 13
v_lshl_add_u32 v11, v2, 7, s42
v_add_u32 v12, 0, v3
v_xor_b32 v12, v12, v10
v_lshl_add_u32 v4, v12, 4, v11
v_add_u32 v12, 2, v3
v_xor_b32 v12, v12, v10
v_lshl_add_u32 v5, v12, 4, v11
v_add_u32 v12, 4, v3
v_xor_b32 v12, v12, v10
v_lshl_add_u32 v6, v12, 4, v11
v_add_u32 v12, 6, v3
v_xor_b32 v12, v12, v10
v_lshl_add_u32 v7, v12, 4, v11
v_bfe_u32 v12, v1, 2, 2
v_lshl_add_u32 v13, v3, 3, v12
v_lshlrev_b32 v13, 8, v13
v_bfe_u32 v14, v1, 4, 1
v_lshl_add_u32 v13, v14, 5, v13
v_and_b32 v14, 3, v1
v_lshl_add_u32 v13, v14, 3, v13
v_add_u32 v13, 0x4000, v13
s_lshl_b32 s42, s47, 1
v_xor_b32 v14, s42, v12
v_lshl_add_u32 v8, v14, 6, v13
v_xor_b32 v9, 64, v8
v_mov_b32 v64, 0
v_mov_b32 v65, 0
v_mov_b32 v66, 0
v_mov_b32 v67, 0
v_mov_b32 v68, 0
v_mov_b32 v69, 0
v_mov_b32 v70, 0
v_mov_b32 v71, 0
v_mov_b32 v72, 0
v_mov_b32 v73, 0
v_mov_b32 v74, 0
v_mov_b32 v75, 0
v_mov_b32 v76, 0
v_mov_b32 v77, 0
v_mov_b32 v78, 0
v_mov_b32 v79, 0
v_mov_b32 v80, 0
v_mov_b32 v81, 0
v_mov_b32 v82, 0
v_mov_b32 v83, 0
v_mov_b32 v84, 0
v_mov_b32 v85, 0
v_mov_b32 v86, 0
v_mov_b32 v87, 0
v_mov_b32 v88, 0
v_mov_b32 v89, 0
v_mov_b32 v90, 0
v_mov_b32 v91, 0
v_mov_b32 v92, 0
v_mov_b32 v93, 0
v_mov_b32 v94, 0
v_mov_b32 v95, 0
v_mov_b32 v96, 0
v_mov_b32 v97, 0
v_mov_b32 v98, 0
v_mov_b32 v99, 0
v_mov_b32 v100, 0
v_mov_b32 v101, 0
v_mov_b32 v102, 0
v_mov_b32 v103, 0
v_mov_b32 v104, 0
v_mov_b32 v105, 0
v_mov_b32 v106, 0
v_mov_b32 v107, 0
v_mov_b32 v108, 0
v_mov_b32 v109, 0
v_mov_b32 v110, 0
v_mov_b32 v111, 0
v_mov_b32 v112, 0
v_mov_b32 v113, 0
v_mov_b32 v114, 0
v_mov_b32 v115, 0
v_mov_b32 v116, 0
v_mov_b32 v117, 0
v_mov_b32 v118, 0
v_mov_b32 v119, 0
v_mov_b32 v120, 0
v_mov_b32 v121, 0
v_mov_b32 v122, 0
v_mov_b32 v123, 0
v_mov_b32 v124, 0
v_mov_b32 v125, 0
v_mov_b32 v126, 0
v_mov_b32 v127, 0
v_mov_b32 v136, 0
v_mov_b32 v137, 0
v_mov_b32 v138, 0
v_mov_b32 v139, 0
v_mov_b32 v140, 0
v_mov_b32 v141, 0
v_mov_b32 v142, 0
v_mov_b32 v143, 0
v_mov_b32 v152, 0
v_mov_b32 v153, 0
v_mov_b32 v154, 0
v_mov_b32 v155, 0
v_mov_b32 v156, 0
v_mov_b32 v157, 0
v_mov_b32 v158, 0
v_mov_b32 v159, 0
v_mov_b32 v160, 0
v_mov_b32 v161, 0
v_mov_b32 v162, 0
v_mov_b32 v163, 0
v_mov_b32 v164, 0
v_mov_b32 v165, 0
v_mov_b32 v166, 0
v_mov_b32 v167, 0
v_mov_b32 v168, 0
v_mov_b32 v169, 0
v_mov_b32 v170, 0
v_mov_b32 v171, 0
v_mov_b32 v172, 0
v_mov_b32 v173, 0
v_mov_b32 v174, 0
v_mov_b32 v175, 0
v_mov_b32 v180, 0
v_mov_b32 v181, 0
v_mov_b32 v182, 0
v_mov_b32 v183, 0
v_mov_b32 v184, 0
v_mov_b32 v185, 0
v_mov_b32 v186, 0
v_mov_b32 v187, 0
v_bfe_u32 v12, v1, 4, 1
v_and_b32 v13, 1, v1
v_cmp_eq_u32 vcc, v12, v13
v_cmp_eq_u32 s[56:57], 1, v12
v_mov_b32 v14, 0x3f803f80
v_cndmask_b32 v176, 0, v14, vcc
v_mov_b32 v177, v176
v_mov_b32 v178, v176
v_mov_b32 v179, v176
s_cmp_ge_u32 s41, 8
s_cbranch_scc1 L_g_v
s_mov_b32 s44, 0
L_g_loopq:
s_waitcnt lgkmcnt(0)
s_barrier
s_waitcnt lgkmcnt(3)
v_mfma_f32_32x32x16_bf16 v[64:79], v[152:155], v[136:139], v[64:79]
ds_read_b128 v[128:131], v4 offset:0
ds_read_b64_tr_b16 v[144:145], v8 offset:0
ds_read_b64_tr_b16 v[146:147], v8 offset:1024
v_mfma_f32_16x16x32_bf16 v[180:183], v[176:179], v[152:155], v[180:183]
s_waitcnt lgkmcnt(4)
v_mfma_f32_32x32x16_bf16 v[80:95], v[156:159], v[136:139], v[80:95]
ds_read_b64_tr_b16 v[148:149], v9 offset:0
ds_read_b64_tr_b16 v[150:151], v9 offset:1024
ds_read_b128 v[132:135], v4 offset:4096
v_mfma_f32_16x16x32_bf16 v[184:187], v[176:179], v[156:159], v[184:187]
s_waitcnt lgkmcnt(6)
v_mfma_f32_32x32x16_bf16 v[96:111], v[152:155], v[140:143], v[96:111]
v_mfma_f32_32x32x16_bf16 v[112:127], v[156:159], v[140:143], v[112:127]
s_waitcnt lgkmcnt(3)
v_mfma_f32_32x32x16_bf16 v[64:79], v[144:147], v[128:131], v[64:79]
ds_read_b128 v[136:139], v5 offset:0
ds_read_b64_tr_b16 v[152:153], v8 offset:4096
ds_read_b64_tr_b16 v[154:155], v8 offset:5120
v_mfma_f32_16x16x32_bf16 v[180:183], v[176:179], v[144:147], v[180:183]
s_waitcnt lgkmcnt(4)
v_mfma_f32_32x32x16_bf16 v[80:95], v[148:151], v[128:131], v[80:95]
ds_read_b64_tr_b16 v[156:157], v9 offset:4096
ds_read_b64_tr_b16 v[158:159], v9 offset:5120
ds_read_b128 v[140:143], v5 offset:4096
v_mfma_f32_16x16x32_bf16 v[184:187], v[176:179], v[148:151], v[184:187]
s_waitcnt lgkmcnt(6)
v_mfma_f32_32x32x16_bf16 v[96:111], v[144:147], v[132:135], v[96:111]
v_mfma_f32_32x32x16_bf16 v[112:127], v[148:151], v[132:135], v[112:127]
s_waitcnt lgkmcnt(3)
v_mfma_f32_32x32x16_bf16 v[64:79], v[152:155], v[136:139], v[64:79]
ds_read_b128 v[128:131], v6 offset:0
ds_read_b64_tr_b16 v[144:145], v8 offset:8192
ds_read_b64_tr_b16 v[146:147], v8 offset:9216
v_mfma_f32_16x16x32_bf16 v[180:183], v[176:179], v[152:155], v[180:183]
s_waitcnt lgkmcnt(4)
v_mfma_f32_32x32x16_bf16 v[80:95], v[156:159], v[136:139], v[80:95]
ds_read_b64_tr_b16 v[148:149], v9 offset:8192
ds_read_b64_tr_b16 v[150:151], v9 offset:9216
ds_read_b128 v[132:135], v6 offset:4096
v_mfma_f32_16x16x32_bf16 v[184:187], v[176:179], v[156:159], v[184:187]
s_waitcnt lgkmcnt(6)
v_mfma_f32_32x32x16_bf16 v[96:111], v[152:155], v[140:143], v[96:111]
v_mfma_f32_32x32x16_bf16 v[112:127], v[156:159], v[140:143], v[112:127]
s_waitcnt lgkmcnt(3)
v_mfma_f32_32x32x16_bf16 v[64:79], v[144:147], v[128:131], v[64:79]
ds_read_b128 v[136:139], v7 offset:0
ds_read_b64_tr_b16 v[152:153], v8 offset:12288
ds_read_b64_tr_b16 v[154:155], v8 offset:13312
v_mfma_f32_16x16x32_bf16 v[180:183], v[176:179], v[144:147], v[180:183]
s_waitcnt lgkmcnt(4)
v_mfma_f32_32x32x16_bf16 v[80:95], v[148:151], v[128:131], v[80:95]
ds_read_b64_tr_b16 v[156:157], v9 offset:12288
ds_read_b64_tr_b16 v[158:159], v9 offset:13312
ds_read_b128 v[140:143], v7 offset:4096
v_mfma_f32_16x16x32_bf16 v[184:187], v[176:179], v[148:151], v[184:187]
s_waitcnt lgkmcnt(6)
v_mfma_f32_32x32x16_bf16 v[96:111], v[144:147], v[132:135], v[96:111]
v_add_u32 v4, 0x8000, v4
v_add_u32 v5, 0x8000, v5
v_add_u32 v6, 0x8000, v6
v_and_b32 v4, 0x1ffff, v4
v_and_b32 v5, 0x1ffff, v5
v_and_b32 v6, 0x1ffff, v6
v_mfma_f32_32x32x16_bf16 v[112:127], v[148:151], v[132:135], v[112:127]
v_add_u32 v7, 0x8000, v7
v_add_u32 v8, 0x8000, v8
v_add_u32 v9, 0x8000, v9
v_and_b32 v7, 0x1ffff, v7
v_and_b32 v8, 0x1ffff, v8
v_and_b32 v9, 0x1ffff, v9
s_add_u32 s44, s44, 1
s_cmp_lt_u32 s44, 8
s_cbranch_scc1 L_g_loopq
v_lshlrev_b32 v18, 2, v2
s_lshl_b32 s42, s46, 8
s_add_u32 s42, s42, 131072
v_add_u32 v19, s42, v18
ds_read_b32 v10, v19 offset:0
ds_read_b32 v11, v19 offset:128
ds_read_b32 v12, v19 offset:512
ds_read_b32 v14, v19 offset:640
s_waitcnt lgkmcnt(4)
v_mfma_f32_16x16x32_bf16 v[180:183], v[176:179], v[152:155], v[180:183]
v_mfma_f32_16x16x32_bf16 v[184:187], v[176:179], v[156:159], v[184:187]
v_mfma_f32_32x32x16_bf16 v[64:79], v[152:155], v[136:139], v[64:79]
v_mfma_f32_32x32x16_bf16 v[80:95], v[156:159], v[136:139], v[80:95]
v_mfma_f32_32x32x16_bf16 v[96:111], v[152:155], v[140:143], v[96:111]
v_mfma_f32_32x32x16_bf16 v[112:127], v[156:159], v[140:143], v[112:127]
s_and_b32 s42, s41, 3
s_lshl_b32 s42, s42, 3
s_lshl_b32 s43, s47, 2
s_add_u32 s42, s42, s43
s_lshl_b32 s42, s42, 16
s_lshl_b32 s43, s40, 2
s_lshl_b32 s50, s46, 1
s_add_u32 s43, s43, s50
s_lshl_b32 s43, s43, 10
s_add_u32 s50, s42, s43
s_lshr_b32 s42, s41, 2
s_lshl_b32 s42, s42, 21
s_add_u32 s50, s50, s42
s_waitcnt lgkmcnt(2)
v_sub_f32 v20, 0, v10
v_cvt_pk_bf16_f32 v160, v20, 0
v_sub_f32 v20, 0, v11
v_cvt_pk_bf16_f32 v164, v20, 0
v_cndmask_b32 v16, v180, v181, s[56:57]
v_cndmask_b32 v17, v184, v185, s[56:57]
v_cvt_pk_bf16_f32 v20, v16, v16
v_and_b32 v20, 0xffff0000, v20
v_sub_f32 v20, v16, v20
v_cndmask_b32 v20, v16, v20, s[48:49]
v_cvt_pk_bf16_f32 v168, v20, 0
v_cvt_pk_bf16_f32 v20, v17, v17
v_and_b32 v20, 0xffff0000, v20
v_sub_f32 v20, v17, v20
v_cndmask_b32 v20, v17, v20, s[48:49]
v_cvt_pk_bf16_f32 v172, v20, 0
s_nop 1
v_mfma_f32_32x32x16_bf16 v[64:79], v[168:171], v[160:163], v[64:79]
v_mfma_f32_32x32x16_bf16 v[80:95], v[172:175], v[160:163], v[80:95]
v_mfma_f32_32x32x16_bf16 v[96:111], v[168:171], v[164:167], v[96:111]
v_mfma_f32_32x32x16_bf16 v[112:127], v[172:175], v[164:167], v[112:127]
s_cmp_lt_u32 s41, 4
s_cselect_b32 s51, 0x3eb8aa3b, 1.0
v_lshlrev_b32 v21, 4, v1
s_waitcnt lgkmcnt(0)
v_mul_f32 v12, s51, v12
v_mul_f32 v14, s51, v14
s_nop 4
v_pk_mul_f32 v[64:65], v[64:65], v[12:13] op_sel_hi:[1,0]
v_pk_mul_f32 v[66:67], v[66:67], v[12:13] op_sel_hi:[1,0]
v_pk_mul_f32 v[68:69], v[68:69], v[12:13] op_sel_hi:[1,0]
v_pk_mul_f32 v[70:71], v[70:71], v[12:13] op_sel_hi:[1,0]
v_pk_mul_f32 v[72:73], v[72:73], v[12:13] op_sel_hi:[1,0]
v_pk_mul_f32 v[74:75], v[74:75], v[12:13] op_sel_hi:[1,0]
v_pk_mul_f32 v[76:77], v[76:77], v[12:13] op_sel_hi:[1,0]
v_pk_mul_f32 v[78:79], v[78:79], v[12:13] op_sel_hi:[1,0]
v_cvt_pk_bf16_f32 v64, v64, v65
v_cvt_pk_bf16_f32 v65, v66, v67
v_cvt_pk_bf16_f32 v66, v68, v69
v_cvt_pk_bf16_f32 v67, v70, v71
v_cvt_pk_bf16_f32 v68, v72, v73
v_cvt_pk_bf16_f32 v69, v74, v75
v_cvt_pk_bf16_f32 v70, v76, v77
v_cvt_pk_bf16_f32 v71, v78, v79
s_add_u32 s52, s50, 0
s_add_u32 s53, s52, 0x10000
buffer_store_dwordx4 v[64:67], v21, s[32:35], s52 offen sc1
buffer_store_dwordx4 v[68:71], v21, s[32:35], s53 offen sc1
v_pk_mul_f32 v[80:81], v[80:81], v[12:13] op_sel_hi:[1,0]
v_pk_mul_f32 v[82:83], v[82:83], v[12:13] op_sel_hi:[1,0]
v_pk_mul_f32 v[84:85], v[84:85], v[12:13] op_sel_hi:[1,0]
v_pk_mul_f32 v[86:87], v[86:87], v[12:13] op_sel_hi:[1,0]
v_pk_mul_f32 v[88:89], v[88:89], v[12:13] op_sel_hi:[1,0]
v_pk_mul_f32 v[90:91], v[90:91], v[12:13] op_sel_hi:[1,0]
v_pk_mul_f32 v[92:93], v[92:93], v[12:13] op_sel_hi:[1,0]
v_pk_mul_f32 v[94:95], v[94:95], v[12:13] op_sel_hi:[1,0]
v_cvt_pk_bf16_f32 v80, v80, v81
v_cvt_pk_bf16_f32 v81, v82, v83
v_cvt_pk_bf16_f32 v82, v84, v85
v_cvt_pk_bf16_f32 v83, v86, v87
v_cvt_pk_bf16_f32 v84, v88, v89
v_cvt_pk_bf16_f32 v85, v90, v91
v_cvt_pk_bf16_f32 v86, v92, v93
v_cvt_pk_bf16_f32 v87, v94, v95
s_add_u32 s52, s50, 131072
s_add_u32 s53, s52, 0x10000
buffer_store_dwordx4 v[80:83], v21, s[32:35], s52 offen sc1
buffer_store_dwordx4 v[84:87], v21, s[32:35], s53 offen sc1
v_pk_mul_f32 v[96:97], v[96:97], v[14:15] op_sel_hi:[1,0]
v_pk_mul_f32 v[98:99], v[98:99], v[14:15] op_sel_hi:[1,0]
v_pk_mul_f32 v[100:101], v[100:101], v[14:15] op_sel_hi:[1,0]
v_pk_mul_f32 v[102:103], v[102:103], v[14:15] op_sel_hi:[1,0]
v_pk_mul_f32 v[104:105], v[104:105], v[14:15] op_sel_hi:[1,0]
v_pk_mul_f32 v[106:107], v[106:107], v[14:15] op_sel_hi:[1,0]
v_pk_mul_f32 v[108:109], v[108:109], v[14:15] op_sel_hi:[1,0]
v_pk_mul_f32 v[110:111], v[110:111], v[14:15] op_sel_hi:[1,0]
v_cvt_pk_bf16_f32 v96, v96, v97
v_cvt_pk_bf16_f32 v97, v98, v99
v_cvt_pk_bf16_f32 v98, v100, v101
v_cvt_pk_bf16_f32 v99, v102, v103
v_cvt_pk_bf16_f32 v100, v104, v105
v_cvt_pk_bf16_f32 v101, v106, v107
v_cvt_pk_bf16_f32 v102, v108, v109
v_cvt_pk_bf16_f32 v103, v110, v111
s_add_u32 s52, s50, 1024
s_add_u32 s53, s52, 0x10000
buffer_store_dwordx4 v[96:99], v21, s[32:35], s52 offen sc1
buffer_store_dwordx4 v[100:103], v21, s[32:35], s53 offen sc1
v_pk_mul_f32 v[112:113], v[112:113], v[14:15] op_sel_hi:[1,0]
v_pk_mul_f32 v[114:115], v[114:115], v[14:15] op_sel_hi:[1,0]
v_pk_mul_f32 v[116:117], v[116:117], v[14:15] op_sel_hi:[1,0]
v_pk_mul_f32 v[118:119], v[118:119], v[14:15] op_sel_hi:[1,0]
v_pk_mul_f32 v[120:121], v[120:121], v[14:15] op_sel_hi:[1,0]
v_pk_mul_f32 v[122:123], v[122:123], v[14:15] op_sel_hi:[1,0]
v_pk_mul_f32 v[124:125], v[124:125], v[14:15] op_sel_hi:[1,0]
v_pk_mul_f32 v[126:127], v[126:127], v[14:15] op_sel_hi:[1,0]
v_cvt_pk_bf16_f32 v112, v112, v113
v_cvt_pk_bf16_f32 v113, v114, v115
v_cvt_pk_bf16_f32 v114, v116, v117
v_cvt_pk_bf16_f32 v115, v118, v119
v_cvt_pk_bf16_f32 v116, v120, v121
v_cvt_pk_bf16_f32 v117, v122, v123
v_cvt_pk_bf16_f32 v118, v124, v125
v_cvt_pk_bf16_f32 v119, v126, v127
s_add_u32 s52, s50, 132096
s_add_u32 s53, s52, 0x10000
buffer_store_dwordx4 v[112:115], v21, s[32:35], s52 offen sc1
buffer_store_dwordx4 v[116:119], v21, s[32:35], s53 offen sc1
s_branch L_g_fin
L_g_v:
s_mov_b32 s44, 0
L_g_loopv:
s_waitcnt lgkmcnt(0)
s_barrier
s_waitcnt lgkmcnt(3)
v_mfma_f32_32x32x16_bf16 v[64:79], v[136:139], v[152:155], v[64:79]
ds_read_b128 v[128:131], v4 offset:0
ds_read_b64_tr_b16 v[144:145], v8 offset:0
ds_read_b64_tr_b16 v[146:147], v8 offset:1024
v_mfma_f32_16x16x32_bf16 v[180:183], v[176:179], v[152:155], v[180:183]
s_waitcnt lgkmcnt(4)
v_mfma_f32_32x32x16_bf16 v[80:95], v[136:139], v[156:159], v[80:95]
ds_read_b64_tr_b16 v[148:149], v9 offset:0
ds_read_b64_tr_b16 v[150:151], v9 offset:1024
ds_read_b128 v[132:135], v4 offset:4096
v_mfma_f32_16x16x32_bf16 v[184:187], v[176:179], v[156:159], v[184:187]
s_waitcnt lgkmcnt(6)
v_mfma_f32_32x32x16_bf16 v[96:111], v[140:143], v[152:155], v[96:111]
v_mfma_f32_32x32x16_bf16 v[112:127], v[140:143], v[156:159], v[112:127]
s_waitcnt lgkmcnt(3)
v_mfma_f32_32x32x16_bf16 v[64:79], v[128:131], v[144:147], v[64:79]
ds_read_b128 v[136:139], v5 offset:0
ds_read_b64_tr_b16 v[152:153], v8 offset:4096
ds_read_b64_tr_b16 v[154:155], v8 offset:5120
v_mfma_f32_16x16x32_bf16 v[180:183], v[176:179], v[144:147], v[180:183]
s_waitcnt lgkmcnt(4)
v_mfma_f32_32x32x16_bf16 v[80:95], v[128:131], v[148:151], v[80:95]
ds_read_b64_tr_b16 v[156:157], v9 offset:4096
ds_read_b64_tr_b16 v[158:159], v9 offset:5120
ds_read_b128 v[140:143], v5 offset:4096
v_mfma_f32_16x16x32_bf16 v[184:187], v[176:179], v[148:151], v[184:187]
s_waitcnt lgkmcnt(6)
v_mfma_f32_32x32x16_bf16 v[96:111], v[132:135], v[144:147], v[96:111]
v_mfma_f32_32x32x16_bf16 v[112:127], v[132:135], v[148:151], v[112:127]
s_waitcnt lgkmcnt(3)
v_mfma_f32_32x32x16_bf16 v[64:79], v[136:139], v[152:155], v[64:79]
ds_read_b128 v[128:131], v6 offset:0
ds_read_b64_tr_b16 v[144:145], v8 offset:8192
ds_read_b64_tr_b16 v[146:147], v8 offset:9216
v_mfma_f32_16x16x32_bf16 v[180:183], v[176:179], v[152:155], v[180:183]
s_waitcnt lgkmcnt(4)
v_mfma_f32_32x32x16_bf16 v[80:95], v[136:139], v[156:159], v[80:95]
ds_read_b64_tr_b16 v[148:149], v9 offset:8192
ds_read_b64_tr_b16 v[150:151], v9 offset:9216
ds_read_b128 v[132:135], v6 offset:4096
v_mfma_f32_16x16x32_bf16 v[184:187], v[176:179], v[156:159], v[184:187]
s_waitcnt lgkmcnt(6)
v_mfma_f32_32x32x16_bf16 v[96:111], v[140:143], v[152:155], v[96:111]
v_mfma_f32_32x32x16_bf16 v[112:127], v[140:143], v[156:159], v[112:127]
s_waitcnt lgkmcnt(3)
v_mfma_f32_32x32x16_bf16 v[64:79], v[128:131], v[144:147], v[64:79]
ds_read_b128 v[136:139], v7 offset:0
ds_read_b64_tr_b16 v[152:153], v8 offset:12288
ds_read_b64_tr_b16 v[154:155], v8 offset:13312
v_mfma_f32_16x16x32_bf16 v[180:183], v[176:179], v[144:147], v[180:183]
s_waitcnt lgkmcnt(4)
v_mfma_f32_32x32x16_bf16 v[80:95], v[128:131], v[148:151], v[80:95]
ds_read_b64_tr_b16 v[156:157], v9 offset:12288
ds_read_b64_tr_b16 v[158:159], v9 offset:13312
ds_read_b128 v[140:143], v7 offset:4096
v_mfma_f32_16x16x32_bf16 v[184:187], v[176:179], v[148:151], v[184:187]
s_waitcnt lgkmcnt(6)
v_mfma_f32_32x32x16_bf16 v[96:111], v[132:135], v[144:147], v[96:111]
v_add_u32 v4, 0x8000, v4
v_add_u32 v5, 0x8000, v5
v_add_u32 v6, 0x8000, v6
v_and_b32 v4, 0x1ffff, v4
v_and_b32 v5, 0x1ffff, v5
v_and_b32 v6, 0x1ffff, v6
v_mfma_f32_32x32x16_bf16 v[112:127], v[132:135], v[148:151], v[112:127]
v_add_u32 v7, 0x8000, v7
v_add_u32 v8, 0x8000, v8
v_add_u32 v9, 0x8000, v9
v_and_b32 v7, 0x1ffff, v7
v_and_b32 v8, 0x1ffff, v8
v_and_b32 v9, 0x1ffff, v9
s_add_u32 s44, s44, 1
s_cmp_lt_u32 s44, 8
s_cbranch_scc1 L_g_loopv
v_lshlrev_b32 v18, 2, v2
s_lshl_b32 s42, s46, 8
s_add_u32 s42, s42, 131072
v_add_u32 v19, s42, v18
ds_read_b32 v10, v19 offset:0
ds_read_b32 v11, v19 offset:128
v_lshl_add_u32 v19, v3, 4, s42
ds_read_b128 v[24:27], v19 offset:512
ds_read_b128 v[28:31], v19 offset:544
ds_read_b128 v[32:35], v19 offset:576
ds_read_b128 v[36:39], v19 offset:608
ds_read_b128 v[40:43], v19 offset:640
ds_read_b128 v[44:47], v19 offset:672
ds_read_b128 v[48:51], v19 offset:704
ds_read_b128 v[52:55], v19 offset:736
s_waitcnt lgkmcnt(10)
v_mfma_f32_16x16x32_bf16 v[180:183], v[176:179], v[152:155], v[180:183]
v_mfma_f32_16x16x32_bf16 v[184:187], v[176:179], v[156:159], v[184:187]
v_mfma_f32_32x32x16_bf16 v[64:79], v[136:139], v[152:155], v[64:79]
v_mfma_f32_32x32x16_bf16 v[80:95], v[136:139], v[156:159], v[80:95]
v_mfma_f32_32x32x16_bf16 v[96:111], v[140:143], v[152:155], v[96:111]
v_mfma_f32_32x32x16_bf16 v[112:127], v[140:143], v[156:159], v[112:127]
s_and_b32 s42, s41, 3
s_lshl_b32 s42, s42, 3
s_lshl_b32 s43, s47, 2
s_add_u32 s42, s42, s43
s_lshl_b32 s42, s42, 16
s_lshl_b32 s43, s40, 2
s_lshl_b32 s50, s46, 1
s_add_u32 s43, s43, s50
s_lshl_b32 s43, s43, 10
s_add_u32 s50, s42, s43
s_lshr_b32 s42, s41, 2
s_lshl_b32 s42, s42, 21
s_add_u32 s50, s50, s42
s_waitcnt lgkmcnt(8)
v_sub_f32 v20, 0, v10
v_cvt_pk_bf16_f32 v160, v20, 0
v_sub_f32 v20, 0, v11
v_cvt_pk_bf16_f32 v164, v20, 0
v_cndmask_b32 v16, v180, v181, s[56:57]
v_cndmask_b32 v17, v184, v185, s[56:57]
v_cvt_pk_bf16_f32 v20, v16, v16
v_and_b32 v20, 0xffff0000, v20
v_sub_f32 v20, v16, v20
v_cndmask_b32 v20, v16, v20, s[48:49]
v_cvt_pk_bf16_f32 v168, v20, 0
v_cvt_pk_bf16_f32 v20, v17, v17
v_and_b32 v20, 0xffff0000, v20
v_sub_f32 v20, v17, v20
v_cndmask_b32 v20, v17, v20, s[48:49]
v_cvt_pk_bf16_f32 v172, v20, 0
s_nop 1
v_mfma_f32_32x32x16_bf16 v[64:79], v[160:163], v[168:171], v[64:79]
v_mfma_f32_32x32x16_bf16 v[80:95], v[160:163], v[172:175], v[80:95]
v_mfma_f32_32x32x16_bf16 v[96:111], v[164:167], v[168:171], v[96:111]
v_mfma_f32_32x32x16_bf16 v[112:127], v[164:167], v[172:175], v[112:127]
v_bfe_u32 v21, v1, 4, 1
v_lshlrev_b32 v21, 16, v21
v_lshl_add_u32 v21, v3, 8, v21
v_and_b32 v22, 15, v1
v_lshl_add_u32 v21, v22, 4, v21
s_waitcnt lgkmcnt(0)
s_nop 4
v_pk_mul_f32 v[64:65], v[64:65], v[24:25]
v_pk_mul_f32 v[66:67], v[66:67], v[26:27]
v_pk_mul_f32 v[68:69], v[68:69], v[28:29]
v_pk_mul_f32 v[70:71], v[70:71], v[30:31]
v_pk_mul_f32 v[72:73], v[72:73], v[32:33]
v_pk_mul_f32 v[74:75], v[74:75], v[34:35]
v_pk_mul_f32 v[76:77], v[76:77], v[36:37]
v_pk_mul_f32 v[78:79], v[78:79], v[38:39]
v_cvt_pk_bf16_f32 v64, v64, v65
v_cvt_pk_bf16_f32 v65, v66, v67
v_cvt_pk_bf16_f32 v66, v68, v69
v_cvt_pk_bf16_f32 v67, v70, v71
v_cvt_pk_bf16_f32 v68, v72, v73
v_cvt_pk_bf16_f32 v69, v74, v75
v_cvt_pk_bf16_f32 v70, v76, v77
v_cvt_pk_bf16_f32 v71, v78, v79
s_add_u32 s52, s50, 0
buffer_store_dwordx4 v[64:67], v21, s[32:35], s52 offen sc1
buffer_store_dwordx4 v[68:71], v21, s[32:35], s52 offen offset:512 sc1
v_pk_mul_f32 v[80:81], v[80:81], v[24:25]
v_pk_mul_f32 v[82:83], v[82:83], v[26:27]
v_pk_mul_f32 v[84:85], v[84:85], v[28:29]
v_pk_mul_f32 v[86:87], v[86:87], v[30:31]
v_pk_mul_f32 v[88:89], v[88:89], v[32:33]
v_pk_mul_f32 v[90:91], v[90:91], v[34:35]
v_pk_mul_f32 v[92:93], v[92:93], v[36:37]
v_pk_mul_f32 v[94:95], v[94:95], v[38:39]
v_cvt_pk_bf16_f32 v80, v80, v81
v_cvt_pk_bf16_f32 v81, v82, v83
v_cvt_pk_bf16_f32 v82, v84, v85
v_cvt_pk_bf16_f32 v83, v86, v87
v_cvt_pk_bf16_f32 v84, v88, v89
v_cvt_pk_bf16_f32 v85, v90, v91
v_cvt_pk_bf16_f32 v86, v92, v93
v_cvt_pk_bf16_f32 v87, v94, v95
s_add_u32 s52, s50, 131072
buffer_store_dwordx4 v[80:83], v21, s[32:35], s52 offen sc1
buffer_store_dwordx4 v[84:87], v21, s[32:35], s52 offen offset:512 sc1
v_pk_mul_f32 v[96:97], v[96:97], v[40:41]
v_pk_mul_f32 v[98:99], v[98:99], v[42:43]
v_pk_mul_f32 v[100:101], v[100:101], v[44:45]
v_pk_mul_f32 v[102:103], v[102:103], v[46:47]
v_pk_mul_f32 v[104:105], v[104:105], v[48:49]
v_pk_mul_f32 v[106:107], v[106:107], v[50:51]
v_pk_mul_f32 v[108:109], v[108:109], v[52:53]
v_pk_mul_f32 v[110:111], v[110:111], v[54:55]
v_cvt_pk_bf16_f32 v96, v96, v97
v_cvt_pk_bf16_f32 v97, v98, v99
v_cvt_pk_bf16_f32 v98, v100, v101
v_cvt_pk_bf16_f32 v99, v102, v103
v_cvt_pk_bf16_f32 v100, v104, v105
v_cvt_pk_bf16_f32 v101, v106, v107
v_cvt_pk_bf16_f32 v102, v108, v109
v_cvt_pk_bf16_f32 v103, v110, v111
s_add_u32 s52, s50, 1024
buffer_store_dwordx4 v[96:99], v21, s[32:35], s52 offen sc1
buffer_store_dwordx4 v[100:103], v21, s[32:35], s52 offen offset:512 sc1
v_pk_mul_f32 v[112:113], v[112:113], v[40:41]
v_pk_mul_f32 v[114:115], v[114:115], v[42:43]
v_pk_mul_f32 v[116:117], v[116:117], v[44:45]
v_pk_mul_f32 v[118:119], v[118:119], v[46:47]
v_pk_mul_f32 v[120:121], v[120:121], v[48:49]
v_pk_mul_f32 v[122:123], v[122:123], v[50:51]
v_pk_mul_f32 v[124:125], v[124:125], v[52:53]
v_pk_mul_f32 v[126:127], v[126:127], v[54:55]
v_cvt_pk_bf16_f32 v112, v112, v113
v_cvt_pk_bf16_f32 v113, v114, v115
v_cvt_pk_bf16_f32 v114, v116, v117
v_cvt_pk_bf16_f32 v115, v118, v119
v_cvt_pk_bf16_f32 v116, v120, v121
v_cvt_pk_bf16_f32 v117, v122, v123
v_cvt_pk_bf16_f32 v118, v124, v125
v_cvt_pk_bf16_f32 v119, v126, v127
s_add_u32 s52, s50, 132096
buffer_store_dwordx4 v[112:115], v21, s[32:35], s52 offen sc1
buffer_store_dwordx4 v[116:119], v21, s[32:35], s52 offen offset:512 sc1
L_g_fin:
s_endpgm
L_k1_aux:
s_waitcnt lgkmcnt(0)
s_or_b32 s24, s2, s3
s_cmp_lg_u32 s24, 0
s_cbranch_scc1 L_k1_non
s_memrealtime s[60:61]
s_mov_b32 s24, s20
s_mov_b32 s25, s21
s_mov_b32 s26, 0x100
s_mov_b32 s27, 0x20000
v_mov_b32 v3, 0
s_waitcnt lgkmcnt(0)
s_or_b32 s60, s60, 1
v_mov_b32 v4, s60
s_mov_b32 exec_lo, 1
s_mov_b32 exec_hi, 0
buffer_store_dword v4, v3, s[24:27], 0 offen sc1
s_mov_b64 exec, -1
L_k1_non:
s_cmp_gt_u32 s2, 32
s_cbranch_scc1 L_k1_touch
s_cmp_eq_u32 s2, 32
s_cbranch_scc1 L_k1_topk
s_mov_b32 s24, s4
s_mov_b32 s25, s5
s_mov_b32 s26, 0x200000
s_mov_b32 s27, 0x20000
s_mov_b32 s40, s12
s_mov_b32 s41, s13
s_mov_b32 s42, 0x400
s_mov_b32 s43, 0x20000
s_and_b32 s44, s2, 1
s_bfe_u32 s45, s2, 0x20001
s_lshr_b32 s46, s2, 3
s_lshl_b32 s49, s45, 3
s_lshl_b32 s47, s44, 2
s_add_u32 s49, s49, s47
s_add_u32 s49, s49, s46
v_lshrrev_b32 v2, 4, v1
v_and_b32 v3, 15, v1
v_lshlrev_b32 v3, 4, v3
v_lshl_add_u32 v4, v2, 10, v3
s_lshl_b32 s44, s49, 6
s_lshl_b32 s45, s3, 3
s_add_u32 s46, s44, s45
s_lshl_b32 s47, s46, 10
buffer_load_dwordx4 v[32:35], v4, s[24:27], s47 offen offset:0
buffer_load_dwordx4 v[36:39], v4, s[24:27], s47 offen offset:256
buffer_load_dwordx4 v[40:43], v4, s[24:27], s47 offen offset:512
buffer_load_dwordx4 v[44:47], v4, s[24:27], s47 offen offset:768
buffer_load_dwordx4 v[16:19], v3, s[40:43], 0 offen offset:0
buffer_load_dwordx4 v[20:23], v3, s[40:43], 0 offen offset:256
buffer_load_dwordx4 v[24:27], v3, s[40:43], 0 offen offset:512
buffer_load_dwordx4 v[28:31], v3, s[40:43], 0 offen offset:768
s_add_u32 s47, s47, 4096
buffer_load_dwordx4 v[48:51], v4, s[24:27], s47 offen offset:0
buffer_load_dwordx4 v[52:55], v4, s[24:27], s47 offen offset:256
buffer_load_dwordx4 v[56:59], v4, s[24:27], s47 offen offset:512
buffer_load_dwordx4 v[60:63], v4, s[24:27], s47 offen offset:768
s_mov_b32 s36, s20
s_mov_b32 s37, s21
s_mov_b32 s38, 0x100
s_mov_b32 s39, 0x20000
v_mov_b32 v13, 0
buffer_load_dword v12, v13, s[36:39], 0 offen sc1
s_mov_b32 s32, s22
s_mov_b32 s33, s23
s_mov_b32 s34, 0x900000
s_mov_b32 s35, 0x20000
v_mov_b32 v5, 0x3f803f80
v_mov_b32 v8, 0
v_add_u32 v15, s46, v2
s_waitcnt vmcnt(5)
v_dot2_f32_bf16 v8, v16, v5, v8
v_dot2_f32_bf16 v8, v17, v5, v8
v_dot2_f32_bf16 v8, v18, v5, v8
v_dot2_f32_bf16 v8, v19, v5, v8
v_dot2_f32_bf16 v8, v20, v5, v8
v_dot2_f32_bf16 v8, v21, v5, v8
v_dot2_f32_bf16 v8, v22, v5, v8
v_dot2_f32_bf16 v8, v23, v5, v8
v_dot2_f32_bf16 v8, v24, v5, v8
v_dot2_f32_bf16 v8, v25, v5, v8
v_dot2_f32_bf16 v8, v26, v5, v8
v_dot2_f32_bf16 v8, v27, v5, v8
v_dot2_f32_bf16 v8, v28, v5, v8
v_dot2_f32_bf16 v8, v29, v5, v8
v_dot2_f32_bf16 v8, v30, v5, v8
v_dot2_f32_bf16 v8, v31, v5, v8
v_mov_b32 v9, 0
v_mov_b32 v10, 0
v_mov_b32 v11, 0
v_dot2_f32_bf16 v9, v32, v5, v9
v_dot2_f32_bf16 v10, v32, v32, v10
v_dot2_f32_bf16 v11, v32, v16, v11
v_dot2_f32_bf16 v9, v33, v5, v9
v_dot2_f32_bf16 v10, v33, v33, v10
v_dot2_f32_bf16 v11, v33, v17, v11
v_dot2_f32_bf16 v9, v34, v5, v9
v_dot2_f32_bf16 v10, v34, v34, v10
v_dot2_f32_bf16 v11, v34, v18, v11
v_dot2_f32_bf16 v9, v35, v5, v9
v_dot2_f32_bf16 v10, v35, v35, v10
v_dot2_f32_bf16 v11, v35, v19, v11
v_dot2_f32_bf16 v9, v36, v5, v9
v_dot2_f32_bf16 v10, v36, v36, v10
v_dot2_f32_bf16 v11, v36, v20, v11
v_dot2_f32_bf16 v9, v37, v5, v9
v_dot2_f32_bf16 v10, v37, v37, v10
v_dot2_f32_bf16 v11, v37, v21, v11
v_dot2_f32_bf16 v9, v38, v5, v9
v_dot2_f32_bf16 v10, v38, v38, v10
v_dot2_f32_bf16 v11, v38, v22, v11
v_dot2_f32_bf16 v9, v39, v5, v9
v_dot2_f32_bf16 v10, v39, v39, v10
v_dot2_f32_bf16 v11, v39, v23, v11
v_dot2_f32_bf16 v9, v40, v5, v9
v_dot2_f32_bf16 v10, v40, v40, v10
v_dot2_f32_bf16 v11, v40, v24, v11
v_dot2_f32_bf16 v9, v41, v5, v9
v_dot2_f32_bf16 v10, v41, v41, v10
v_dot2_f32_bf16 v11, v41, v25, v11
v_dot2_f32_bf16 v9, v42, v5, v9
v_dot2_f32_bf16 v10, v42, v42, v10
v_dot2_f32_bf16 v11, v42, v26, v11
v_dot2_f32_bf16 v9, v43, v5, v9
v_dot2_f32_bf16 v10, v43, v43, v10
v_dot2_f32_bf16 v11, v43, v27, v11
v_dot2_f32_bf16 v9, v44, v5, v9
v_dot2_f32_bf16 v10, v44, v44, v10
v_dot2_f32_bf16 v11, v44, v28, v11
v_dot2_f32_bf16 v9, v45, v5, v9
v_dot2_f32_bf16 v10, v45, v45, v10
v_dot2_f32_bf16 v11, v45, v29, v11
v_dot2_f32_bf16 v9, v46, v5, v9
v_dot2_f32_bf16 v10, v46, v46, v10
v_dot2_f32_bf16 v11, v46, v30, v11
v_dot2_f32_bf16 v9, v47, v5, v9
v_dot2_f32_bf16 v10, v47, v47, v10
v_dot2_f32_bf16 v11, v47, v31, v11
s_nop 2
v_add_f32_dpp v9, v9, v9 quad_perm:[1,0,3,2] row_mask:0xf bank_mask:0xf
v_add_f32_dpp v10, v10, v10 quad_perm:[1,0,3,2] row_mask:0xf bank_mask:0xf
v_add_f32_dpp v11, v11, v11 quad_perm:[1,0,3,2] row_mask:0xf bank_mask:0xf
v_add_f32_dpp v8, v8, v8 quad_perm:[1,0,3,2] row_mask:0xf bank_mask:0xf
v_add_f32_dpp v9, v9, v9 quad_perm:[2,3,0,1] row_mask:0xf bank_mask:0xf
v_add_f32_dpp v10, v10, v10 quad_perm:[2,3,0,1] row_mask:0xf bank_mask:0xf
v_add_f32_dpp v11, v11, v11 quad_perm:[2,3,0,1] row_mask:0xf bank_mask:0xf
v_add_f32_dpp v8, v8, v8 quad_perm:[2,3,0,1] row_mask:0xf bank_mask:0xf
v_add_f32_dpp v9, v9, v9 row_half_mirror row_mask:0xf bank_mask:0xf
v_add_f32_dpp v10, v10, v10 row_half_mirror row_mask:0xf bank_mask:0xf
v_add_f32_dpp v11, v11, v11 row_half_mirror row_mask:0xf bank_mask:0xf
v_add_f32_dpp v8, v8, v8 row_half_mirror row_mask:0xf bank_mask:0xf
v_add_f32_dpp v9, v9, v9 row_mirror row_mask:0xf bank_mask:0xf
v_add_f32_dpp v10, v10, v10 row_mirror row_mask:0xf bank_mask:0xf
v_add_f32_dpp v11, v11, v11 row_mirror row_mask:0xf bank_mask:0xf
v_add_f32_dpp v8, v8, v8 row_mirror row_mask:0xf bank_mask:0xf
v_mul_f32 v100, 0x3b000000, v9
v_mul_f32 v14, 0x3b000000, v10
v_fma_f32 v14, -v100, v100, v14
v_max_f32 v14, 0, v14
v_cvt_pk_bf16_f32 v100, v100, v100
v_and_b32 v100, 0xffff0000, v100
v_cvt_pk_bf16_f32 v14, v14, v14
v_and_b32 v14, 0xffff0000, v14
v_add_f32 v14, 0x3727c5ac, v14
v_cvt_pk_bf16_f32 v14, v14, v14
v_and_b32 v14, 0xffff0000, v14
v_sqrt_f32 v14, v14
s_nop 0
v_cvt_pk_bf16_f32 v14, v14, v14
v_and_b32 v14, 0xffff0000, v14
v_rcp_f32 v101, v14
v_fma_f32 v14, -v100, v8, v11
v_mul_f32 v14, v14, v101
v_cvt_pk_bf16_f32 v14, v14, v14
v_and_b32 v14, 0xffff, v14
v_cmp_gt_u32 vcc, 0x8000, v14
v_xor_b32 v96, 0x8000, v14
v_xor_b32 v97, 0xffff, v14
v_sub_u32 v98, 0xffff, v15
v_cndmask_b32 v14, v97, v96, vcc
v_lshl_or_b32 v102, v14, 16, v98
v_add_u32 v15, 4, v15
s_waitcnt vmcnt(1)
v_mov_b32 v9, 0
v_mov_b32 v10, 0
v_mov_b32 v11, 0
v_dot2_f32_bf16 v9, v48, v5, v9
v_dot2_f32_bf16 v10, v48, v48, v10
v_dot2_f32_bf16 v11, v48, v16, v11
v_dot2_f32_bf16 v9, v49, v5, v9
v_dot2_f32_bf16 v10, v49, v49, v10
v_dot2_f32_bf16 v11, v49, v17, v11
v_dot2_f32_bf16 v9, v50, v5, v9
v_dot2_f32_bf16 v10, v50, v50, v10
v_dot2_f32_bf16 v11, v50, v18, v11
v_dot2_f32_bf16 v9, v51, v5, v9
v_dot2_f32_bf16 v10, v51, v51, v10
v_dot2_f32_bf16 v11, v51, v19, v11
v_dot2_f32_bf16 v9, v52, v5, v9
v_dot2_f32_bf16 v10, v52, v52, v10
v_dot2_f32_bf16 v11, v52, v20, v11
v_dot2_f32_bf16 v9, v53, v5, v9
v_dot2_f32_bf16 v10, v53, v53, v10
v_dot2_f32_bf16 v11, v53, v21, v11
v_dot2_f32_bf16 v9, v54, v5, v9
v_dot2_f32_bf16 v10, v54, v54, v10
v_dot2_f32_bf16 v11, v54, v22, v11
v_dot2_f32_bf16 v9, v55, v5, v9
v_dot2_f32_bf16 v10, v55, v55, v10
v_dot2_f32_bf16 v11, v55, v23, v11
v_dot2_f32_bf16 v9, v56, v5, v9
v_dot2_f32_bf16 v10, v56, v56, v10
v_dot2_f32_bf16 v11, v56, v24, v11
v_dot2_f32_bf16 v9, v57, v5, v9
v_dot2_f32_bf16 v10, v57, v57, v10
v_dot2_f32_bf16 v11, v57, v25, v11
v_dot2_f32_bf16 v9, v58, v5, v9
v_dot2_f32_bf16 v10, v58, v58, v10
v_dot2_f32_bf16 v11, v58, v26, v11
v_dot2_f32_bf16 v9, v59, v5, v9
v_dot2_f32_bf16 v10, v59, v59, v10
v_dot2_f32_bf16 v11, v59, v27, v11
v_dot2_f32_bf16 v9, v60, v5, v9
v_dot2_f32_bf16 v10, v60, v60, v10
v_dot2_f32_bf16 v11, v60, v28, v11
v_dot2_f32_bf16 v9, v61, v5, v9
v_dot2_f32_bf16 v10, v61, v61, v10
v_dot2_f32_bf16 v11, v61, v29, v11
v_dot2_f32_bf16 v9, v62, v5, v9
v_dot2_f32_bf16 v10, v62, v62, v10
v_dot2_f32_bf16 v11, v62, v30, v11
v_dot2_f32_bf16 v9, v63, v5, v9
v_dot2_f32_bf16 v10, v63, v63, v10
v_dot2_f32_bf16 v11, v63, v31, v11
s_nop 2
v_add_f32_dpp v9, v9, v9 quad_perm:[1,0,3,2] row_mask:0xf bank_mask:0xf
v_add_f32_dpp v10, v10, v10 quad_perm:[1,0,3,2] row_mask:0xf bank_mask:0xf
v_add_f32_dpp v11, v11, v11 quad_perm:[1,0,3,2] row_mask:0xf bank_mask:0xf
v_add_f32_dpp v9, v9, v9 quad_perm:[2,3,0,1] row_mask:0xf bank_mask:0xf
v_add_f32_dpp v10, v10, v10 quad_perm:[2,3,0,1] row_mask:0xf bank_mask:0xf
v_add_f32_dpp v11, v11, v11 quad_perm:[2,3,0,1] row_mask:0xf bank_mask:0xf
v_add_f32_dpp v9, v9, v9 row_half_mirror row_mask:0xf bank_mask:0xf
v_add_f32_dpp v10, v10, v10 row_half_mirror row_mask:0xf bank_mask:0xf
v_add_f32_dpp v11, v11, v11 row_half_mirror row_mask:0xf bank_mask:0xf
v_add_f32_dpp v9, v9, v9 row_mirror row_mask:0xf bank_mask:0xf
v_add_f32_dpp v10, v10, v10 row_mirror row_mask:0xf bank_mask:0xf
v_add_f32_dpp v11, v11, v11 row_mirror row_mask:0xf bank_mask:0xf
v_mul_f32 v104, 0x3b000000, v9
v_mul_f32 v14, 0x3b000000, v10
v_fma_f32 v14, -v104, v104, v14
v_max_f32 v14, 0, v14
v_cvt_pk_bf16_f32 v104, v104, v104
v_and_b32 v104, 0xffff0000, v104
v_cvt_pk_bf16_f32 v14, v14, v14
v_and_b32 v14, 0xffff0000, v14
v_add_f32 v14, 0x3727c5ac, v14
v_cvt_pk_bf16_f32 v14, v14, v14
v_and_b32 v14, 0xffff0000, v14
v_sqrt_f32 v14, v14
s_nop 0
v_cvt_pk_bf16_f32 v14, v14, v14
v_and_b32 v14, 0xffff0000, v14
v_rcp_f32 v105, v14
v_fma_f32 v14, -v104, v8, v11
v_mul_f32 v14, v14, v105
v_cvt_pk_bf16_f32 v14, v14, v14
v_and_b32 v14, 0xffff, v14
v_cmp_gt_u32 vcc, 0x8000, v14
v_xor_b32 v96, 0x8000, v14
v_xor_b32 v97, 0xffff, v14
v_sub_u32 v98, 0xffff, v15
v_cndmask_b32 v14, v97, v96, vcc
v_lshl_or_b32 v106, v14, 16, v98
v_add_u32 v15, 4, v15
s_waitcnt vmcnt(0)
v_readfirstlane_b32 s51, v12
v_and_b32 v9, 15, v1
v_cmp_eq_u32 vcc, 1, v9
s_nop 1
s_cmp_lg_u32 s51, 0
s_cbranch_scc1 L_e_tag
v_mov_b32 v13, 0
s_mov_b32 s98, 0
L_nonce_e:
buffer_load_dword v12, v13, s[36:39], 0 offen sc1
s_add_u32 s98, s98, 1
s_waitcnt vmcnt(0)
v_readfirstlane_b32 s51, v12
s_cmp_gt_u32 s98, 0x40000
s_cbranch_scc1 L_nonced_e
s_cmp_lg_u32 s51, 0
s_cbranch_scc1 L_nonced_e
s_sleep 4
s_branch L_nonce_e
L_nonced_e:
L_e_tag:
v_cndmask_b32 v100, v100, v104, vcc
v_cndmask_b32 v101, v101, v105, vcc
v_cndmask_b32 v102, v102, v106, vcc
v_mov_b32 v103, s51
v_lshl_add_u32 v10, v9, 2, v2
v_add_u32 v10, s46, v10
v_lshlrev_b32 v10, 4, v10
s_mov_b32 s47, 0x800000
s_mov_b32 exec_lo, 0x00030003
s_mov_b32 exec_hi, 0x00030003
buffer_store_dwordx4 v[100:103], v10, s[32:35], s47 offen sc1
s_mov_b64 exec, -1
L_e_done:
s_endpgm
L_k1_topk:
s_mov_b32 s24, s22
s_mov_b32 s25, s23
s_mov_b32 s26, 0x900000
s_mov_b32 s27, 0x20000
s_mov_b32 s40, s20
s_mov_b32 s41, s21
s_mov_b32 s42, 0x100
s_mov_b32 s43, 0x20000
s_cmp_ge_u32 s3, 4
s_cbranch_scc1 L_tk_sync
v_mov_b32 v13, 0
s_mov_b32 s98, 0
L_nonce_tk:
buffer_load_dword v12, v13, s[40:43], 0 offen sc1
s_add_u32 s98, s98, 1
s_waitcnt vmcnt(0)
v_readfirstlane_b32 s48, v12
s_cmp_gt_u32 s98, 0x40000
s_cbranch_scc1 L_nonced_tk
s_cmp_lg_u32 s48, 0
s_cbranch_scc1 L_nonced_tk
s_sleep 4
s_branch L_nonce_tk
L_nonced_tk:
v_lshlrev_b32 v3, 4, v0
s_mov_b32 s98, 0
L_tk_poll:
s_mov_b32 s45, 0x800000
buffer_load_dwordx2 v[96:97], v3, s[24:27], s45 offen offset:8 sc1
s_add_u32 s45, s45, 4096
buffer_load_dwordx2 v[98:99], v3, s[24:27], s45 offen offset:8 sc1
s_add_u32 s45, s45, 4096
buffer_load_dwordx2 v[100:101], v3, s[24:27], s45 offen offset:8 sc1
s_add_u32 s45, s45, 4096
buffer_load_dwordx2 v[102:103], v3, s[24:27], s45 offen offset:8 sc1
s_add_u32 s45, s45, 4096
buffer_load_dwordx2 v[104:105], v3, s[24:27], s45 offen offset:8 sc1
s_add_u32 s45, s45, 4096
buffer_load_dwordx2 v[106:107], v3, s[24:27], s45 offen offset:8 sc1
s_add_u32 s45, s45, 4096
buffer_load_dwordx2 v[108:109], v3, s[24:27], s45 offen offset:8 sc1
s_add_u32 s45, s45, 4096
buffer_load_dwordx2 v[110:111], v3, s[24:27], s45 offen offset:8 sc1
s_add_u32 s98, s98, 1
s_waitcnt vmcnt(0)
v_xor_b32 v97, s48, v97
v_xor_b32 v99, s48, v99
v_xor_b32 v101, s48, v101
v_xor_b32 v103, s48, v103
v_xor_b32 v105, s48, v105
v_xor_b32 v107, s48, v107
v_xor_b32 v109, s48, v109
v_xor_b32 v111, s48, v111
v_or3_b32 v4, v97, v99, v101
v_or3_b32 v5, v103, v105, v107
v_or3_b32 v4, v4, v109, v111
v_or_b32 v4, v4, v5
v_cmp_ne_u32 vcc, 0, v4
s_cmp_gt_u32 s98, 0x40000
s_cbranch_scc1 L_tk_go
s_cmp_eq_u64 vcc, 0
s_cbranch_scc1 L_tk_go
s_sleep 2
s_branch L_tk_poll
L_tk_go:
v_max_u32 v97, v96, v98
v_min_u32 v99, v96, v98
v_max_u32 v101, v100, v102
v_min_u32 v103, v100, v102
v_max_u32 v105, v104, v106
v_min_u32 v107, v104, v106
v_max_u32 v109, v108, v110
v_min_u32 v111, v108, v110
v_max_u32 v14, v97, v101
v_min_u32 v15, v97, v101
v_max_u32 v16, v99, v103
v_min_u32 v17, v99, v103
v_max_u32 v18, v105, v109
v_min_u32 v19, v105, v109
v_max_u32 v20, v107, v111
v_min_u32 v21, v107, v111
v_max_u32 v22, v16, v15
v_min_u32 v23, v16, v15
v_max_u32 v112, v20, v19
v_min_u32 v113, v20, v19
v_max_u32 v96, v14, v18
v_min_u32 v98, v14, v18
v_max_u32 v100, v17, v21
v_min_u32 v102, v17, v21
v_max_u32 v104, v22, v112
v_min_u32 v106, v22, v112
v_max_u32 v108, v23, v113
v_min_u32 v110, v23, v113
v_max_u32 v97, v104, v98
v_min_u32 v101, v104, v98
v_max_u32 v99, v100, v110
v_min_u32 v103, v100, v110
v_max_u32 v105, v108, v101
v_min_u32 v109, v108, v101
v_max_u32 v107, v99, v106
v_min_u32 v111, v99, v106
v_max_u32 v16, v107, v109
v_min_u32 v15, v107, v109
s_nop 0
v_max_u32_dpp v20, v96, v102 quad_perm:[1,0,3,2] row_mask:0xf bank_mask:0xf
v_max_u32_dpp v19, v97, v103 quad_perm:[1,0,3,2] row_mask:0xf bank_mask:0xf
v_max_u32_dpp v14, v105, v111 quad_perm:[1,0,3,2] row_mask:0xf bank_mask:0xf
v_max_u32_dpp v18, v16, v15 quad_perm:[1,0,3,2] row_mask:0xf bank_mask:0xf
v_max_u32_dpp v17, v15, v16 quad_perm:[1,0,3,2] row_mask:0xf bank_mask:0xf
v_max_u32_dpp v21, v111, v105 quad_perm:[1,0,3,2] row_mask:0xf bank_mask:0xf
v_max_u32_dpp v22, v103, v97 quad_perm:[1,0,3,2] row_mask:0xf bank_mask:0xf
v_max_u32_dpp v112, v102, v96 quad_perm:[1,0,3,2] row_mask:0xf bank_mask:0xf
v_max_u32 v23, v112, v18
v_min_u32 v113, v112, v18
v_max_u32 v104, v22, v14
v_min_u32 v98, v22, v14
v_max_u32 v100, v21, v19
v_min_u32 v110, v21, v19
v_max_u32 v108, v17, v20
v_min_u32 v101, v17, v20
v_max_u32 v99, v23, v100
v_min_u32 v106, v23, v100
v_max_u32 v107, v104, v108
v_min_u32 v109, v104, v108
v_max_u32 v96, v113, v110
v_min_u32 v97, v113, v110
v_max_u32 v105, v98, v101
v_min_u32 v16, v98, v101
v_max_u32 v15, v99, v107
v_min_u32 v111, v99, v107
v_max_u32 v103, v106, v109
v_min_u32 v102, v106, v109
v_max_u32 v112, v96, v105
v_min_u32 v18, v96, v105
v_max_u32 v22, v97, v16
v_min_u32 v14, v97, v16
v_max_u32_dpp v21, v15, v14 quad_perm:[2,3,0,1] row_mask:0xf bank_mask:0xf
v_max_u32_dpp v19, v111, v22 quad_perm:[2,3,0,1] row_mask:0xf bank_mask:0xf
v_max_u32_dpp v17, v103, v18 quad_perm:[2,3,0,1] row_mask:0xf bank_mask:0xf
v_max_u32_dpp v20, v102, v112 quad_perm:[2,3,0,1] row_mask:0xf bank_mask:0xf
v_max_u32_dpp v23, v112, v102 quad_perm:[2,3,0,1] row_mask:0xf bank_mask:0xf
v_max_u32_dpp v100, v18, v103 quad_perm:[2,3,0,1] row_mask:0xf bank_mask:0xf
v_max_u32_dpp v104, v22, v111 quad_perm:[2,3,0,1] row_mask:0xf bank_mask:0xf
v_max_u32_dpp v108, v14, v15 quad_perm:[2,3,0,1] row_mask:0xf bank_mask:0xf
v_max_u32 v113, v108, v20
v_min_u32 v110, v108, v20
v_max_u32 v98, v104, v17
v_min_u32 v101, v104, v17
v_max_u32 v99, v100, v19
v_min_u32 v107, v100, v19
v_max_u32 v106, v23, v21
v_min_u32 v109, v23, v21
v_max_u32 v96, v113, v99
v_min_u32 v105, v113, v99
v_max_u32 v97, v98, v106
v_min_u32 v16, v98, v106
v_max_u32 v15, v110, v107
v_min_u32 v111, v110, v107
v_max_u32 v103, v101, v109
v_min_u32 v102, v101, v109
v_max_u32 v112, v96, v97
v_min_u32 v18, v96, v97
v_max_u32 v22, v105, v16
v_min_u32 v14, v105, v16
v_max_u32 v108, v15, v103
v_min_u32 v20, v15, v103
v_max_u32 v104, v111, v102
v_min_u32 v17, v111, v102
v_max_u32_dpp v100, v112, v17 row_half_mirror row_mask:0xf bank_mask:0xf
v_max_u32_dpp v19, v18, v104 row_half_mirror row_mask:0xf bank_mask:0xf
v_max_u32_dpp v23, v22, v20 row_half_mirror row_mask:0xf bank_mask:0xf
v_max_u32_dpp v21, v14, v108 row_half_mirror row_mask:0xf bank_mask:0xf
v_max_u32_dpp v113, v108, v14 row_half_mirror row_mask:0xf bank_mask:0xf
v_max_u32_dpp v99, v20, v22 row_half_mirror row_mask:0xf bank_mask:0xf
v_max_u32_dpp v98, v104, v18 row_half_mirror row_mask:0xf bank_mask:0xf
v_max_u32_dpp v106, v17, v112 row_half_mirror row_mask:0xf bank_mask:0xf
v_max_u32 v110, v106, v21
v_min_u32 v107, v106, v21
v_max_u32 v101, v98, v23
v_min_u32 v109, v98, v23
v_max_u32 v96, v99, v19
v_min_u32 v97, v99, v19
v_max_u32 v105, v113, v100
v_min_u32 v16, v113, v100
v_max_u32 v15, v110, v96
v_min_u32 v103, v110, v96
v_max_u32 v111, v101, v105
v_min_u32 v102, v101, v105
v_max_u32 v112, v107, v97
v_min_u32 v18, v107, v97
v_max_u32 v22, v109, v16
v_min_u32 v14, v109, v16
v_max_u32 v108, v15, v111
v_min_u32 v20, v15, v111
v_max_u32 v104, v103, v102
v_min_u32 v17, v103, v102
v_max_u32 v106, v112, v22
v_min_u32 v21, v112, v22
v_max_u32 v98, v18, v14
v_min_u32 v23, v18, v14
v_max_u32_dpp v99, v108, v23 row_mirror row_mask:0xf bank_mask:0xf
v_max_u32_dpp v19, v20, v98 row_mirror row_mask:0xf bank_mask:0xf
v_max_u32_dpp v113, v104, v21 row_mirror row_mask:0xf bank_mask:0xf
v_max_u32_dpp v100, v17, v106 row_mirror row_mask:0xf bank_mask:0xf
v_max_u32_dpp v110, v106, v17 row_mirror row_mask:0xf bank_mask:0xf
v_max_u32_dpp v96, v21, v104 row_mirror row_mask:0xf bank_mask:0xf
v_max_u32_dpp v101, v98, v20 row_mirror row_mask:0xf bank_mask:0xf
v_max_u32_dpp v105, v23, v108 row_mirror row_mask:0xf bank_mask:0xf
v_max_u32 v107, v105, v100
v_min_u32 v97, v105, v100
v_max_u32 v109, v101, v113
v_min_u32 v16, v101, v113
v_max_u32 v15, v96, v19
v_min_u32 v111, v96, v19
v_max_u32 v103, v110, v99
v_min_u32 v102, v110, v99
v_max_u32 v112, v107, v15
v_min_u32 v22, v107, v15
v_max_u32 v18, v109, v103
v_min_u32 v14, v109, v103
v_max_u32 v108, v97, v111
v_min_u32 v20, v97, v111
v_max_u32 v104, v16, v102
v_min_u32 v17, v16, v102
v_max_u32 v106, v112, v18
v_min_u32 v21, v112, v18
v_max_u32 v98, v22, v14
v_min_u32 v23, v22, v14
v_max_u32 v105, v108, v104
v_min_u32 v100, v108, v104
v_max_u32 v101, v20, v17
v_min_u32 v113, v20, v17
v_max_u32_dpp v96, v106, v113 row_bcast:15 row_mask:0xa bank_mask:0xf
v_max_u32_dpp v19, v21, v101 row_bcast:15 row_mask:0xa bank_mask:0xf
v_max_u32_dpp v110, v98, v100 row_bcast:15 row_mask:0xa bank_mask:0xf
v_max_u32_dpp v99, v23, v105 row_bcast:15 row_mask:0xa bank_mask:0xf
v_max_u32_dpp v107, v105, v23 row_bcast:15 row_mask:0xa bank_mask:0xf
v_max_u32_dpp v15, v100, v98 row_bcast:15 row_mask:0xa bank_mask:0xf
v_max_u32_dpp v109, v101, v21 row_bcast:15 row_mask:0xa bank_mask:0xf
v_max_u32_dpp v103, v113, v106 row_bcast:15 row_mask:0xa bank_mask:0xf
v_max_u32 v97, v103, v99
v_min_u32 v111, v103, v99
v_max_u32 v16, v109, v110
v_min_u32 v102, v109, v110
v_max_u32 v112, v15, v19
v_min_u32 v18, v15, v19
v_max_u32 v22, v107, v96
v_min_u32 v14, v107, v96
v_max_u32 v108, v97, v112
v_min_u32 v104, v97, v112
v_max_u32 v20, v16, v22
v_min_u32 v17, v16, v22
v_max_u32 v106, v111, v18
v_min_u32 v21, v111, v18
v_max_u32 v98, v102, v14
v_min_u32 v23, v102, v14
v_max_u32 v105, v108, v20
v_min_u32 v100, v108, v20
v_max_u32 v101, v104, v17
v_min_u32 v113, v104, v17
v_max_u32 v103, v106, v98
v_min_u32 v99, v106, v98
v_max_u32 v109, v21, v23
v_min_u32 v110, v21, v23
v_max_u32_dpp v15, v105, v110 row_bcast:31 row_mask:0xc bank_mask:0xf
v_max_u32_dpp v19, v100, v109 row_bcast:31 row_mask:0xc bank_mask:0xf
v_max_u32_dpp v107, v101, v99 row_bcast:31 row_mask:0xc bank_mask:0xf
v_max_u32_dpp v96, v113, v103 row_bcast:31 row_mask:0xc bank_mask:0xf
v_max_u32_dpp v97, v103, v113 row_bcast:31 row_mask:0xc bank_mask:0xf
v_max_u32_dpp v112, v99, v101 row_bcast:31 row_mask:0xc bank_mask:0xf
v_max_u32_dpp v16, v109, v100 row_bcast:31 row_mask:0xc bank_mask:0xf
v_max_u32_dpp v22, v110, v105 row_bcast:31 row_mask:0xc bank_mask:0xf
v_max_u32 v111, v22, v96
v_min_u32 v18, v22, v96
v_max_u32 v102, v16, v107
v_min_u32 v14, v16, v107
v_max_u32 v108, v112, v19
v_min_u32 v20, v112, v19
v_max_u32 v104, v97, v15
v_min_u32 v17, v97, v15
v_max_u32 v106, v111, v108
v_min_u32 v98, v111, v108
v_max_u32 v21, v102, v104
v_min_u32 v23, v102, v104
v_max_u32 v105, v18, v20
v_min_u32 v100, v18, v20
v_max_u32 v101, v14, v17
v_min_u32 v113, v14, v17
v_max_u32 v103, v106, v21
v_min_u32 v99, v106, v21
v_max_u32 v109, v98, v23
v_min_u32 v110, v98, v23
v_max_u32 v22, v105, v101
v_min_u32 v96, v105, v101
v_max_u32 v16, v100, v113
v_min_u32 v107, v100, v113
v_mov_b32 v116, v103
v_mov_b32 v117, v99
v_mov_b32 v118, v109
v_mov_b32 v119, v110
v_mov_b32 v120, v22
v_mov_b32 v121, v96
v_mov_b32 v122, v16
v_mov_b32 v123, v107
s_lshl_b32 s98, s3, 5
s_add_u32 s98, s98, 0
v_mov_b32 v112, s98
s_mov_b32 exec_lo, 0
s_mov_b32 exec_hi, 0x80000000
ds_write_b128 v112, v[116:119]
ds_write_b128 v112, v[120:123] offset:16
s_mov_b64 exec, -1
s_waitcnt lgkmcnt(0)
L_tk_sync:
s_barrier
s_cmp_lg_u32 s3, 0
s_cbranch_scc1 L_tk_done
v_mbcnt_lo_u32_b32 v96, -1, 0
v_mbcnt_hi_u32_b32 v96, -1, v96
v_and_b32 v96, 3, v96
v_lshlrev_b32 v96, 5, v96
v_add_u32 v96, 0, v96
ds_read_b128 v[116:119], v96
ds_read_b128 v[120:123], v96 offset:16
s_waitcnt lgkmcnt(0)
v_max_u32_dpp v97, v116, v123 quad_perm:[1,0,3,2] row_mask:0xf bank_mask:0xf
v_max_u32_dpp v98, v117, v122 quad_perm:[1,0,3,2] row_mask:0xf bank_mask:0xf
v_max_u32_dpp v99, v118, v121 quad_perm:[1,0,3,2] row_mask:0xf bank_mask:0xf
v_max_u32_dpp v100, v119, v120 quad_perm:[1,0,3,2] row_mask:0xf bank_mask:0xf
v_max_u32_dpp v101, v120, v119 quad_perm:[1,0,3,2] row_mask:0xf bank_mask:0xf
v_max_u32_dpp v102, v121, v118 quad_perm:[1,0,3,2] row_mask:0xf bank_mask:0xf
v_max_u32_dpp v103, v122, v117 quad_perm:[1,0,3,2] row_mask:0xf bank_mask:0xf
v_max_u32_dpp v104, v123, v116 quad_perm:[1,0,3,2] row_mask:0xf bank_mask:0xf
v_max_u32 v105, v104, v100
v_min_u32 v106, v104, v100
v_max_u32 v107, v103, v99
v_min_u32 v108, v103, v99
v_max_u32 v109, v102, v98
v_min_u32 v110, v102, v98
v_max_u32 v111, v101, v97
v_min_u32 v112, v101, v97
v_max_u32 v113, v105, v109
v_min_u32 v116, v105, v109
v_max_u32 v117, v107, v111
v_min_u32 v118, v107, v111
v_max_u32 v119, v106, v110
v_min_u32 v120, v106, v110
v_max_u32 v121, v108, v112
v_min_u32 v122, v108, v112
v_max_u32 v123, v113, v117
v_min_u32 v104, v113, v117
v_max_u32 v100, v116, v118
v_min_u32 v103, v116, v118
v_max_u32 v99, v119, v121
v_min_u32 v102, v119, v121
v_max_u32 v98, v120, v122
v_min_u32 v101, v120, v122
v_max_u32_dpp v97, v123, v101 quad_perm:[2,3,0,1] row_mask:0xf bank_mask:0xf
v_max_u32_dpp v105, v104, v98 quad_perm:[2,3,0,1] row_mask:0xf bank_mask:0xf
v_max_u32_dpp v109, v100, v102 quad_perm:[2,3,0,1] row_mask:0xf bank_mask:0xf
v_max_u32_dpp v107, v103, v99 quad_perm:[2,3,0,1] row_mask:0xf bank_mask:0xf
v_max_u32_dpp v111, v99, v103 quad_perm:[2,3,0,1] row_mask:0xf bank_mask:0xf
v_max_u32_dpp v106, v102, v100 quad_perm:[2,3,0,1] row_mask:0xf bank_mask:0xf
v_max_u32_dpp v110, v98, v104 quad_perm:[2,3,0,1] row_mask:0xf bank_mask:0xf
v_max_u32_dpp v108, v101, v123 quad_perm:[2,3,0,1] row_mask:0xf bank_mask:0xf
v_max_u32 v112, v108, v107
v_min_u32 v113, v108, v107
v_max_u32 v117, v110, v109
v_min_u32 v116, v110, v109
v_max_u32 v118, v106, v105
v_min_u32 v119, v106, v105
v_max_u32 v121, v111, v97
v_min_u32 v120, v111, v97
v_max_u32 v122, v112, v118
v_min_u32 v123, v112, v118
v_max_u32 v104, v117, v121
v_min_u32 v100, v117, v121
v_max_u32 v103, v113, v119
v_min_u32 v99, v113, v119
v_max_u32 v102, v116, v120
v_min_u32 v98, v116, v120
v_max_u32 v101, v122, v104
v_min_u32 v108, v122, v104
v_max_u32 v107, v123, v100
v_min_u32 v110, v123, v100
v_max_u32 v109, v103, v102
v_min_u32 v106, v103, v102
v_max_u32 v105, v99, v98
v_min_u32 v111, v99, v98
v_mov_b32 v20, v101
v_cmp_eq_u32 vcc, 1, v1
s_nop 1
v_cndmask_b32 v20, v20, v108, vcc
v_cmp_eq_u32 vcc, 2, v1
s_nop 1
v_cndmask_b32 v20, v20, v107, vcc
v_cmp_eq_u32 vcc, 3, v1
s_nop 1
v_cndmask_b32 v20, v20, v110, vcc
v_cmp_eq_u32 vcc, 4, v1
s_nop 1
v_cndmask_b32 v20, v20, v109, vcc
v_cmp_eq_u32 vcc, 5, v1
s_nop 1
v_cndmask_b32 v20, v20, v106, vcc
v_cmp_eq_u32 vcc, 6, v1
s_nop 1
v_cndmask_b32 v20, v20, v105, vcc
v_cmp_eq_u32 vcc, 7, v1
s_nop 1
v_cndmask_b32 v20, v20, v111, vcc
v_and_b32 v8, 0xffff, v20
v_sub_u32 v8, 0xffff, v8
v_lshrrev_b32 v9, 16, v20
v_cmp_le_u32 vcc, 0x8000, v9
v_xor_b32 v10, 0x8000, v9
v_xor_b32 v11, 0xffff, v9
v_cndmask_b32 v9, v11, v10, vcc
v_lshlrev_b32 v9, 16, v9
v_mul_f32 v9, 0xbfb8aa3b, v9
v_exp_f32 v9, v9
s_nop 0
v_add_f32 v9, 1.0, v9
v_rcp_f32 v9, v9
s_nop 0
v_cvt_pk_bf16_f32 v9, v9, v9
v_and_b32 v9, 0xffff0000, v9
v_lshlrev_b32 v10, 2, v1
s_mov_b32 s45, 0x80e000
s_mov_b32 exec_lo, 0xff
s_mov_b32 exec_hi, 0
buffer_store_dword v8, v10, s[24:27], s45 offen
buffer_store_dword v9, v10, s[24:27], s45 offen offset:32
s_mov_b64 exec, -1
L_tk_done:
s_endpgm
L_k1_touch:
s_mov_b32 s32, s6
s_mov_b32 s33, s7
s_mov_b32 s34, 0x180000
s_mov_b32 s35, 0x20000
s_sub_u32 s46, s2, 33
s_lshl_b32 s46, s46, 3
s_add_u32 s46, s46, s3
s_cmp_ge_u32 s46, 168
s_cbranch_scc1 L_pf_part
v_lshlrev_b32 v11, 7, v1
s_lshl_b32 s49, s46, 13
s_add_u32 s49, s49, 196608
buffer_load_dword v40, v11, s[32:35], s49 offen
L_pf_part:
L_pf_end:
s_endpgm
L_k1_end:
s_endpgm
.globl k2_kernel
.p2align 8
.type k2_kernel,@function
k2_kernel:

s_cmp_ge_u32 s2, 256
s_cbranch_scc1 L_k2_end
s_load_dwordx2 s[6:7], s[0:1], 80
v_lshrrev_b32 v2, 6, v0
v_and_b32 v1, 63, v0
v_readfirstlane_b32 s22, v2
s_cmp_lt_u32 s2, 28
s_cbranch_scc1 L_k2_mixed
s_cmp_ge_u32 s22, 8
s_cbranch_scc1 L_k2_end
s_branch L_k2_attn
L_k2_mixed:
s_load_dwordx2 s[84:85], s[0:1], 0
s_load_dwordx4 s[88:91], s[0:1], 40
s_load_dwordx2 s[92:93], s[0:1], 56
s_cmp_lg_u32 s22, 0
s_cbranch_scc1 L_k2_z
v_mov_b32 v3, 8160
v_mov_b32 v4, 0
v_mov_b32 v5, 0
v_mov_b32 v6, 0
v_mov_b32 v7, 0
ds_write_b128 v3, v[4:7]
s_waitcnt lgkmcnt(0)
L_k2_z:
s_barrier
s_cmp_ge_u32 s22, 8
s_cbranch_scc1 L_k2_moe
L_k2_attn:
s_sub_u32 s19, 11, s22
s_cmp_lt_u32 s22, 4
s_cselect_b32 s19, s22, s19
s_and_b32 s20, s2, 7
s_bfe_u32 s27, s2, 0x20003
s_lshl_b32 s27, s27, 3
s_add_u32 s20, s20, s27
s_lshr_b32 s21, s2, 5
v_lshlrev_b32 v9, 4, v1
s_lshl_b32 s23, s21, 3
s_add_u32 s23, s23, s19
s_lshl_b32 s24, s20, 6
s_add_u32 s24, s24, s23
s_lshl_b32 s24, s24, 10
s_lshl_b32 s28, s19, 10
s_waitcnt lgkmcnt(0)
s_mov_b32 s8, s6
s_mov_b32 s9, s7
s_mov_b32 s10, 0x900000
s_mov_b32 s11, 0x20000
s_add_u32 s27, s24, 0x200000
s_add_u32 m0, s28, 8192
s_nop 0
buffer_load_dwordx4 v9, s[8:11], s27 offen lds
s_add_u32 s27, s24, 0x0
buffer_load_dwordx4 v[116:119], v9, s[8:11], s27 offen
s_cmp_eq_u32 s21, 0
s_cbranch_scc1 L_at_noprev
s_add_u32 s27, s24, 0x1fe000
s_mov_b32 m0, s28
s_nop 0
buffer_load_dwordx4 v9, s[8:11], s27 offen lds
s_add_u32 s27, s24, 0x3fe000
s_add_u32 m0, s28, 16384
s_nop 0
buffer_load_dwordx4 v9, s[8:11], s27 offen lds
L_at_noprev:
s_add_u32 s27, s24, 0x400000
s_add_u32 m0, s28, 24576
s_nop 0
buffer_load_dwordx4 v9, s[8:11], s27 offen lds
s_cmp_ge_u32 s2, 28
s_cbranch_scc1 L_at_iss
v_mov_b32 v10, 8172
v_mov_b32 v11, 1
s_mov_b64 s[34:35], exec
s_mov_b32 exec_lo, 1
s_mov_b32 exec_hi, 0
s_waitcnt lgkmcnt(0)
ds_add_u32 v10, v11
s_mov_b64 exec, s[34:35]
L_at_iss:
v_and_b32 v6, 31, v1
v_lshrrev_b32 v7, 5, v1
v_lshlrev_b32 v8, 2, v7
v_sub_u32 v8, v6, v8
v_cmp_gt_i32 s[40:41], 0, v8
v_cmp_gt_i32 s[42:43], 1, v8
v_cmp_gt_i32 s[44:45], 2, v8
v_cmp_gt_i32 s[46:47], 3, v8
v_cmp_gt_i32 s[48:49], 8, v8
v_cmp_gt_i32 s[50:51], 9, v8
v_cmp_gt_i32 s[52:53], 10, v8
v_cmp_gt_i32 s[54:55], 11, v8
v_cmp_gt_i32 s[56:57], 16, v8
v_cmp_gt_i32 s[58:59], 17, v8
v_cmp_gt_i32 s[60:61], 18, v8
v_cmp_gt_i32 s[62:63], 19, v8
v_cmp_gt_i32 s[64:65], 24, v8
v_cmp_gt_i32 s[66:67], 25, v8
v_cmp_gt_i32 s[68:69], 26, v8
v_cmp_gt_i32 s[70:71], 27, v8
v_mov_b32 v10, 0xffff
v_mov_b32 v11, 0xffff0000
v_cndmask_b32 v88, 0, v10, s[40:41]
v_cndmask_b32 v12, 0, v11, s[42:43]
v_or_b32 v88, v88, v12
v_cndmask_b32 v89, 0, v10, s[44:45]
v_cndmask_b32 v12, 0, v11, s[46:47]
v_or_b32 v89, v89, v12
v_cndmask_b32 v90, 0, v10, s[48:49]
v_cndmask_b32 v12, 0, v11, s[50:51]
v_or_b32 v90, v90, v12
v_cndmask_b32 v91, 0, v10, s[52:53]
v_cndmask_b32 v12, 0, v11, s[54:55]
v_or_b32 v91, v91, v12
v_cndmask_b32 v92, 0, v10, s[56:57]
v_cndmask_b32 v12, 0, v11, s[58:59]
v_or_b32 v92, v92, v12
v_cndmask_b32 v93, 0, v10, s[60:61]
v_cndmask_b32 v12, 0, v11, s[62:63]
v_or_b32 v93, v93, v12
v_cndmask_b32 v94, 0, v10, s[64:65]
v_cndmask_b32 v12, 0, v11, s[66:67]
v_or_b32 v94, v94, v12
v_cndmask_b32 v95, 0, v10, s[68:69]
v_cndmask_b32 v12, 0, v11, s[70:71]
v_or_b32 v95, v95, v12
v_mov_b32 v10, 0x3f803f80
v_mov_b32 v100, v10
v_mov_b32 v101, v10
v_mov_b32 v102, v10
v_mov_b32 v103, v10
v_mov_b32 v104, v10
v_mov_b32 v105, v10
v_mov_b32 v106, v10
v_mov_b32 v107, v10
v_mov_b32 v108, v10
v_mov_b32 v109, v10
v_mov_b32 v110, v10
v_mov_b32 v111, v10
v_mov_b32 v112, v10
v_mov_b32 v113, v10
v_mov_b32 v114, v10
v_mov_b32 v115, v10
v_mov_b32 v64, 0
v_mov_b32 v65, 0
v_mov_b32 v66, 0
v_mov_b32 v67, 0
v_mov_b32 v68, 0
v_mov_b32 v69, 0
v_mov_b32 v70, 0
v_mov_b32 v71, 0
v_mov_b32 v72, 0
v_mov_b32 v73, 0
v_mov_b32 v74, 0
v_mov_b32 v75, 0
v_mov_b32 v76, 0
v_mov_b32 v77, 0
v_mov_b32 v78, 0
v_mov_b32 v79, 0
s_mov_b32 s30, 0xffff
s_mov_b32 s31, 0xffff
s_sub_u32 s25, 8, s19
s_cmp_eq_u32 s21, 0
s_cselect_b32 s25, s25, 1
v_add_u32 v2, s28, v9
v_and_b32 v3, 15, v1
v_lshlrev_b32 v3, 4, v3
v_lshl_add_u32 v3, v7, 8, v3
s_add_u32 s27, s28, 16384
v_add_u32 v3, s27, v3
s_lshl_b32 s27, s25, 10
v_add_u32 v13, s27, v2
v_add_u32 v14, s27, v3
s_mov_b32 s29, s27
s_mov_b32 s37, 0
v_mov_b32 v48, 0
v_mov_b32 v49, 0
v_mov_b32 v50, 0
v_mov_b32 v51, 0
v_mov_b32 v52, 0
v_mov_b32 v53, 0
v_mov_b32 v54, 0
v_mov_b32 v55, 0
v_mov_b32 v56, 0
v_mov_b32 v57, 0
v_mov_b32 v58, 0
v_mov_b32 v59, 0
v_mov_b32 v60, 0
v_mov_b32 v61, 0
v_mov_b32 v62, 0
v_mov_b32 v63, 0
s_cmp_eq_u32 s21, 0
s_cbranch_scc0 L_at_sa
v_mov_b32 v16, 0xf149f2ca
v_mov_b32 v17, 0xf149f2ca
v_mov_b32 v18, 0xf149f2ca
v_mov_b32 v19, 0xf149f2ca
v_mov_b32 v20, 0xf149f2ca
v_mov_b32 v21, 0xf149f2ca
v_mov_b32 v22, 0xf149f2ca
v_mov_b32 v23, 0xf149f2ca
v_mov_b32 v24, 0xf149f2ca
v_mov_b32 v25, 0xf149f2ca
v_mov_b32 v26, 0xf149f2ca
v_mov_b32 v27, 0xf149f2ca
v_mov_b32 v28, 0xf149f2ca
v_mov_b32 v29, 0xf149f2ca
v_mov_b32 v30, 0xf149f2ca
v_mov_b32 v31, 0xf149f2ca
L_at_sa:
s_waitcnt vmcnt(0)
s_cmp_ge_u32 s2, 28
s_cbranch_scc1 L_at_plain
v_mov_b32 v10, 8160
v_mov_b32 v11, 1
s_mov_b64 s[34:35], exec
s_mov_b32 exec_lo, 1
s_mov_b32 exec_hi, 0
s_waitcnt lgkmcnt(0)
ds_add_u32 v10, v11
s_mov_b64 exec, s[34:35]
v_mov_b32 v10, 8160
s_mov_b32 s33, 0
L_sync_at:
ds_read_b32 v11, v10
s_add_u32 s33, s33, 1
s_waitcnt lgkmcnt(0)
v_readfirstlane_b32 s36, v11
s_cmp_gt_u32 s33, 0x100000
s_cbranch_scc1 L_syncd_at
s_cmp_ge_u32 s36, 8
s_cbranch_scc1 L_syncd_at
s_sleep 1
s_branch L_sync_at
L_syncd_at:
s_branch L_at_go
L_at_plain:
s_barrier
L_at_go:
s_cmp_eq_u32 s21, 0
s_cbranch_scc1 L_at_f_no0
ds_read_b128 v[96:99], v2
s_mov_b64 exec, s[30:31]
ds_read_b128 v[108:111], v3
ds_read_b128 v[112:115], v3 offset:512
s_mov_b64 exec, -1
s_branch L_at_p2
L_at_f_no0:
ds_read_b128 v[96:99], v13
L_at_p2:
s_cmp_eq_u32 s21, 0
s_cbranch_scc1 L_at_p2_go
s_waitcnt lgkmcnt(0)
v_mfma_f32_32x32x16_bf16 v[16:31], v[96:99], v[116:119], v[48:63]
ds_read_b128 v[96:99], v13
L_at_p2_go:
s_sub_u32 s26, 8, s25
s_cmp_eq_u32 s26, 0
s_cbranch_scc1 L_at_p2_fin
L_at_p2_loop:
s_mov_b64 exec, s[30:31]
ds_read_b128 v[100:103], v14
ds_read_b128 v[104:107], v14 offset:512
s_mov_b64 exec, -1
s_waitcnt lgkmcnt(2)
v_mfma_f32_32x32x16_bf16 v[32:47], v[96:99], v[116:119], v[48:63]
v_add_u32 v13, 0x400, v13
v_add_u32 v14, 0x400, v14
ds_read_b128 v[96:99], v13
s_sub_u32 s26, s26, 1
s_nop 7
v_exp_f32 v32, v32
v_exp_f32 v33, v33
v_exp_f32 v34, v34
v_exp_f32 v35, v35
v_exp_f32 v36, v36
v_exp_f32 v37, v37
v_exp_f32 v38, v38
v_exp_f32 v39, v39
v_exp_f32 v40, v40
v_exp_f32 v41, v41
v_exp_f32 v42, v42
v_exp_f32 v43, v43
v_exp_f32 v44, v44
v_exp_f32 v45, v45
v_exp_f32 v46, v46
v_exp_f32 v47, v47
v_cvt_pk_bf16_f32 v80, v32, v33
v_cvt_pk_bf16_f32 v81, v34, v35
v_cvt_pk_bf16_f32 v82, v36, v37
v_cvt_pk_bf16_f32 v83, v38, v39
v_cvt_pk_bf16_f32 v84, v40, v41
v_cvt_pk_bf16_f32 v85, v42, v43
v_cvt_pk_bf16_f32 v86, v44, v45
v_cvt_pk_bf16_f32 v87, v46, v47
s_waitcnt lgkmcnt(1)
v_mfma_f32_32x32x16_bf16 v[64:79], v[100:103], v[80:83], v[64:79]
v_mfma_f32_32x32x16_bf16 v[64:79], v[104:107], v[84:87], v[64:79]
s_cmp_lg_u32 s26, 0
s_cbranch_scc1 L_at_p2_loop
L_at_p2_fin:
s_mov_b64 exec, s[30:31]
ds_read_b128 v[100:103], v14
ds_read_b128 v[104:107], v14 offset:512
s_mov_b64 exec, -1
s_waitcnt lgkmcnt(2)
v_mfma_f32_32x32x16_bf16 v[32:47], v[96:99], v[116:119], v[48:63]
s_nop 11
v_cndmask_b32 v32, v32, v16, s[40:41]
v_cndmask_b32 v33, v33, v17, s[42:43]
v_cndmask_b32 v34, v34, v18, s[44:45]
v_cndmask_b32 v35, v35, v19, s[46:47]
v_cndmask_b32 v36, v36, v20, s[48:49]
v_cndmask_b32 v37, v37, v21, s[50:51]
v_cndmask_b32 v38, v38, v22, s[52:53]
v_cndmask_b32 v39, v39, v23, s[54:55]
v_cndmask_b32 v40, v40, v24, s[56:57]
v_cndmask_b32 v41, v41, v25, s[58:59]
v_cndmask_b32 v42, v42, v26, s[60:61]
v_cndmask_b32 v43, v43, v27, s[62:63]
v_cndmask_b32 v44, v44, v28, s[64:65]
v_cndmask_b32 v45, v45, v29, s[66:67]
v_cndmask_b32 v46, v46, v30, s[68:69]
v_cndmask_b32 v47, v47, v31, s[70:71]
v_exp_f32 v32, v32
v_exp_f32 v33, v33
v_exp_f32 v34, v34
v_exp_f32 v35, v35
v_exp_f32 v36, v36
v_exp_f32 v37, v37
v_exp_f32 v38, v38
v_exp_f32 v39, v39
v_exp_f32 v40, v40
v_exp_f32 v41, v41
v_exp_f32 v42, v42
v_exp_f32 v43, v43
v_exp_f32 v44, v44
v_exp_f32 v45, v45
v_exp_f32 v46, v46
v_exp_f32 v47, v47
v_cvt_pk_bf16_f32 v80, v32, v33
v_cvt_pk_bf16_f32 v81, v34, v35
v_cvt_pk_bf16_f32 v82, v36, v37
v_cvt_pk_bf16_f32 v83, v38, v39
v_cvt_pk_bf16_f32 v84, v40, v41
v_cvt_pk_bf16_f32 v85, v42, v43
v_cvt_pk_bf16_f32 v86, v44, v45
v_cvt_pk_bf16_f32 v87, v46, v47
v_and_b32 v16, v80, v88
v_and_b32 v17, v81, v89
v_and_b32 v18, v82, v90
v_and_b32 v19, v83, v91
v_and_b32 v20, v84, v92
v_and_b32 v21, v85, v93
v_and_b32 v22, v86, v94
v_and_b32 v23, v87, v95
v_xor_b32 v80, v80, v16
v_xor_b32 v81, v81, v17
v_xor_b32 v82, v82, v18
v_xor_b32 v83, v83, v19
v_xor_b32 v84, v84, v20
v_xor_b32 v85, v85, v21
v_xor_b32 v86, v86, v22
v_xor_b32 v87, v87, v23
s_waitcnt lgkmcnt(0)
s_nop 0
v_mfma_f32_32x32x16_bf16 v[64:79], v[100:103], v[80:83], v[64:79]
v_mfma_f32_32x32x16_bf16 v[64:79], v[104:107], v[84:87], v[64:79]
s_cmp_eq_u32 s21, 0
s_cbranch_scc1 L_at_fin
v_mfma_f32_32x32x16_bf16 v[64:79], v[108:111], v[16:19], v[64:79]
v_mfma_f32_32x32x16_bf16 v[64:79], v[112:115], v[20:23], v[64:79]
L_at_fin:
s_add_u32 s27, s24, 0x0
s_mov_b32 s38, 0x21800000
s_mov_b32 s39, 0x5d800000
s_nop 8
v_cmp_le_f32 vcc, s38, v72
v_cmp_ge_f32 s[72:73], s39, v72
v_rcp_f32 v10, v72
s_and_b64 vcc, vcc, s[72:73]
s_cmp_eq_u64 vcc, -1
s_cselect_b32 s38, 1, s37
s_cmp_eq_u32 s38, 0
s_cbranch_scc1 L_at_redo
s_nop 0
v_mul_f32 v64, v64, v10
v_mul_f32 v65, v65, v10
v_mul_f32 v66, v66, v10
v_mul_f32 v67, v67, v10
v_mul_f32 v68, v68, v10
v_mul_f32 v69, v69, v10
v_mul_f32 v70, v70, v10
v_mul_f32 v71, v71, v10
v_cvt_pk_bf16_f32 v80, v64, v65
v_cvt_pk_bf16_f32 v81, v66, v67
v_cvt_pk_bf16_f32 v82, v68, v69
v_cvt_pk_bf16_f32 v83, v70, v71
buffer_store_dwordx4 v[80:83], v9, s[8:11], s27 offen sc1
s_endpgm
L_at_redo:
s_mov_b32 s37, 1
v_mov_b32 v64, 0
v_mov_b32 v65, 0
v_mov_b32 v66, 0
v_mov_b32 v67, 0
v_mov_b32 v68, 0
v_mov_b32 v69, 0
v_mov_b32 v70, 0
v_mov_b32 v71, 0
v_mov_b32 v72, 0
v_mov_b32 v73, 0
v_mov_b32 v74, 0
v_mov_b32 v75, 0
v_mov_b32 v76, 0
v_mov_b32 v77, 0
v_mov_b32 v78, 0
v_mov_b32 v79, 0
v_add_u32 v13, s29, v2
v_add_u32 v14, s29, v3
v_mov_b32 v4, 0xf149f2ca
v_mov_b32 v5, 0xf149f2ca
s_cmp_eq_u32 s21, 0
s_cbranch_scc1 L_at_p1_no0
ds_read_b128 v[96:99], v2
s_mov_b64 exec, s[30:31]
ds_read_b128 v[108:111], v3
ds_read_b128 v[112:115], v3 offset:512
s_mov_b64 exec, -1
s_waitcnt lgkmcnt(2)
v_mfma_f32_32x32x16_bf16 v[16:31], v[96:99], v[116:119], 0
s_branch L_at_p1_go
L_at_p1_no0:
v_mov_b32 v16, 0xf149f2ca
v_mov_b32 v17, 0xf149f2ca
v_mov_b32 v18, 0xf149f2ca
v_mov_b32 v19, 0xf149f2ca
v_mov_b32 v20, 0xf149f2ca
v_mov_b32 v21, 0xf149f2ca
v_mov_b32 v22, 0xf149f2ca
v_mov_b32 v23, 0xf149f2ca
v_mov_b32 v24, 0xf149f2ca
v_mov_b32 v25, 0xf149f2ca
v_mov_b32 v26, 0xf149f2ca
v_mov_b32 v27, 0xf149f2ca
v_mov_b32 v28, 0xf149f2ca
v_mov_b32 v29, 0xf149f2ca
v_mov_b32 v30, 0xf149f2ca
v_mov_b32 v31, 0xf149f2ca
L_at_p1_go:
v_mov_b32 v15, v13
ds_read_b128 v[96:99], v15
s_sub_u32 s26, 8, s25
s_cmp_eq_u32 s26, 0
s_cbranch_scc1 L_at_p1_fin
L_at_p1_loop:
s_waitcnt lgkmcnt(0)
v_mfma_f32_32x32x16_bf16 v[32:47], v[96:99], v[116:119], 0
v_add_u32 v15, 0x400, v15
ds_read_b128 v[96:99], v15
s_sub_u32 s26, s26, 1
s_nop 8
v_max3_f32 v4, v4, v32, v33
v_max3_f32 v5, v5, v34, v35
v_max3_f32 v4, v4, v36, v37
v_max3_f32 v5, v5, v38, v39
v_max3_f32 v4, v4, v40, v41
v_max3_f32 v5, v5, v42, v43
v_max3_f32 v4, v4, v44, v45
v_max3_f32 v5, v5, v46, v47
s_cmp_lg_u32 s26, 0
s_cbranch_scc1 L_at_p1_loop
L_at_p1_fin:
s_waitcnt lgkmcnt(0)
v_mfma_f32_32x32x16_bf16 v[32:47], v[96:99], v[116:119], 0
s_cmp_eq_u32 s21, 0
s_cselect_b32 s28, s29, 0
v_add_u32 v15, s28, v2
ds_read_b128 v[96:99], v15
s_nop 7
v_cndmask_b32 v32, v32, v16, s[40:41]
v_cndmask_b32 v33, v33, v17, s[42:43]
v_cndmask_b32 v34, v34, v18, s[44:45]
v_cndmask_b32 v35, v35, v19, s[46:47]
v_cndmask_b32 v36, v36, v20, s[48:49]
v_cndmask_b32 v37, v37, v21, s[50:51]
v_cndmask_b32 v38, v38, v22, s[52:53]
v_cndmask_b32 v39, v39, v23, s[54:55]
v_cndmask_b32 v40, v40, v24, s[56:57]
v_cndmask_b32 v41, v41, v25, s[58:59]
v_cndmask_b32 v42, v42, v26, s[60:61]
v_cndmask_b32 v43, v43, v27, s[62:63]
v_cndmask_b32 v44, v44, v28, s[64:65]
v_cndmask_b32 v45, v45, v29, s[66:67]
v_cndmask_b32 v46, v46, v30, s[68:69]
v_cndmask_b32 v47, v47, v31, s[70:71]
v_max3_f32 v4, v4, v32, v33
v_max3_f32 v5, v5, v34, v35
v_max3_f32 v4, v4, v36, v37
v_max3_f32 v5, v5, v38, v39
v_max3_f32 v4, v4, v40, v41
v_max3_f32 v5, v5, v42, v43
v_max3_f32 v4, v4, v44, v45
v_max3_f32 v5, v5, v46, v47
v_max_f32 v4, v4, v5
v_mov_b32 v5, v4
s_nop 1
v_permlane32_swap_b32 v4, v5
s_nop 0
v_max_f32 v4, v4, v5
v_sub_f32 v48, 0, v4
v_sub_f32 v49, 0, v4
v_sub_f32 v50, 0, v4
v_sub_f32 v51, 0, v4
v_sub_f32 v52, 0, v4
v_sub_f32 v53, 0, v4
v_sub_f32 v54, 0, v4
v_sub_f32 v55, 0, v4
v_sub_f32 v56, 0, v4
v_sub_f32 v57, 0, v4
v_sub_f32 v58, 0, v4
v_sub_f32 v59, 0, v4
v_sub_f32 v60, 0, v4
v_sub_f32 v61, 0, v4
v_sub_f32 v62, 0, v4
v_sub_f32 v63, 0, v4
s_branch L_at_p2
L_k2_moe:
s_sub_u32 s22, s22, 8
s_cmp_ge_u32 s22, 4
s_cbranch_scc1 L_moe_d
s_waitcnt lgkmcnt(0)
s_mov_b32 s8, s6
s_mov_b32 s9, s7
s_mov_b32 s10, 0x900000
s_mov_b32 s11, 0x20000
v_mov_b32 v12, 8172
s_mov_b32 s33, 0
L_sync_go:
ds_read_b32 v13, v12
s_add_u32 s33, s33, 1
s_waitcnt lgkmcnt(0)
v_readfirstlane_b32 s36, v13
s_cmp_gt_u32 s33, 0x100000
s_cbranch_scc1 L_syncd_go
s_cmp_ge_u32 s36, 12
s_cbranch_scc1 L_syncd_go
s_sleep 1
s_branch L_sync_go
L_syncd_go:
s_mul_i32 s28, s22, 10
v_lshrrev_b32 v4, 3, v1
v_and_b32 v5, 7, v1
v_bfe_u32 v6, v4, 1, 1
v_lshlrev_b32 v6, 1, v6
v_xor_b32 v5, v5, v6
v_mul_u32_u24 v4, 0xe00, v4
v_xor_b32 v6, 4, v5
v_lshl_add_u32 v7, v6, 4, v4
v_lshl_add_u32 v4, v5, 4, v4
v_add_u32 v7, 28672, v7
s_mov_b32 s18, 0x1c0000
s_mov_b32 s19, 0x20000
s_add_u32 s29, s28, 10
L_moe_dma_g:
s_cmp_lt_u32 s28, 32
s_cselect_b32 s16, s88, s90
s_cselect_b32 s17, s89, s91
s_and_b32 s82, s28, 31
s_mul_i32 s82, s82, 57344
s_lshl_b32 s83, s2, 7
s_add_u32 s82, s82, s83
s_lshl_b32 s83, s28, 11
s_add_u32 m0, s83, 32768
s_add_u32 s28, s28, 1
buffer_load_dwordx4 v4, s[16:19], s82 offen lds
s_add_u32 m0, m0, 1024
s_cmp_lt_u32 s28, s29
buffer_load_dwordx4 v7, s[16:19], s82 offen lds
s_cbranch_scc1 L_moe_dma_g
v_lshrrev_b32 v8, 4, v1
v_bfe_u32 v9, v1, 2, 2
v_and_b32 v10, 3, v1
v_and_b32 v11, 1, v8
v_lshlrev_b32 v11, 1, v11
v_lshrrev_b32 v12, 1, v9
v_or_b32 v11, v11, v12
v_xor_b32 v11, s22, v11
v_lshl_add_u32 v9, v8, 3, v9
v_lshlrev_b32 v9, 7, v9
v_lshl_add_u32 v9, v11, 5, v9
v_lshl_add_u32 v9, v10, 3, v9
v_add_u32 v9, 32768, v9
v_add_u32 v14, 0x10000, v9
v_and_b32 v10, 3, v1
v_mul_u32_u24 v10, 1056, v10
v_bfe_u32 v11, v1, 2, 1
v_mul_u32_u24 v11, 16512, v11
v_add_u32 v10, v10, v11
v_lshl_add_u32 v10, v8, 4, v10
v_and_b32 v11, 15, v1
v_lshlrev_b32 v11, 7, v11
v_lshl_add_u32 v11, v8, 3, v11
s_lshl_b32 s82, s22, 5
s_add_u32 s82, s82, 4224
v_add_u32 v11, s82, v11
s_waitcnt vmcnt(0)
v_mov_b32 v12, 8164
v_mov_b32 v13, 1
s_mov_b64 s[34:35], exec
s_mov_b32 exec_lo, 1
s_mov_b32 exec_hi, 0
s_waitcnt lgkmcnt(0)
ds_add_u32 v12, v13
s_mov_b64 exec, s[34:35]
v_mov_b32 v12, 8164
s_mov_b32 s33, 0
L_sync_m0:
ds_read_b32 v13, v12
s_add_u32 s33, s33, 1
s_waitcnt lgkmcnt(0)
v_readfirstlane_b32 s36, v13
s_cmp_gt_u32 s33, 0x100000
s_cbranch_scc1 L_syncd_m0
s_cmp_ge_u32 s36, 8
s_cbranch_scc1 L_syncd_m0
s_sleep 1
s_branch L_sync_m0
L_syncd_m0:
ds_read_b64_tr_b16 v[16:17], v9 offset:0
ds_read_b64_tr_b16 v[18:19], v9 offset:512
ds_read_b128 v[48:51], v10 offset:0
ds_read_b64_tr_b16 v[32:33], v14 offset:0
ds_read_b64_tr_b16 v[34:35], v14 offset:512
ds_read_b64_tr_b16 v[20:21], v9 offset:4096
ds_read_b64_tr_b16 v[22:23], v9 offset:4608
ds_read_b128 v[52:55], v10 offset:64
ds_read_b64_tr_b16 v[36:37], v14 offset:4096
ds_read_b64_tr_b16 v[38:39], v14 offset:4608
ds_read_b64_tr_b16 v[24:25], v9 offset:8192
ds_read_b64_tr_b16 v[26:27], v9 offset:8704
ds_read_b128 v[56:59], v10 offset:128
ds_read_b64_tr_b16 v[40:41], v14 offset:8192
ds_read_b64_tr_b16 v[42:43], v14 offset:8704
s_waitcnt lgkmcnt(10)
v_mfma_f32_16x16x32_bf16 v[64:67], v[16:19], v[48:51], 0
v_mfma_f32_16x16x32_bf16 v[68:71], v[32:35], v[48:51], 0
ds_read_b64_tr_b16 v[28:29], v9 offset:12288
ds_read_b64_tr_b16 v[30:31], v9 offset:12800
ds_read_b128 v[60:63], v10 offset:192
ds_read_b64_tr_b16 v[44:45], v14 offset:12288
ds_read_b64_tr_b16 v[46:47], v14 offset:12800
s_waitcnt lgkmcnt(10)
v_mfma_f32_16x16x32_bf16 v[64:67], v[20:23], v[52:55], v[64:67]
v_mfma_f32_16x16x32_bf16 v[68:71], v[36:39], v[52:55], v[68:71]
ds_read_b64_tr_b16 v[16:17], v9 offset:16384
ds_read_b64_tr_b16 v[18:19], v9 offset:16896
ds_read_b128 v[48:51], v10 offset:256
ds_read_b64_tr_b16 v[32:33], v14 offset:16384
ds_read_b64_tr_b16 v[34:35], v14 offset:16896
s_waitcnt lgkmcnt(10)
v_mfma_f32_16x16x32_bf16 v[64:67], v[24:27], v[56:59], v[64:67]
v_mfma_f32_16x16x32_bf16 v[68:71], v[40:43], v[56:59], v[68:71]
ds_read_b64_tr_b16 v[20:21], v9 offset:20480
ds_read_b64_tr_b16 v[22:23], v9 offset:20992
ds_read_b128 v[52:55], v10 offset:320
ds_read_b64_tr_b16 v[36:37], v14 offset:20480
ds_read_b64_tr_b16 v[38:39], v14 offset:20992
s_waitcnt lgkmcnt(10)
v_mfma_f32_16x16x32_bf16 v[64:67], v[28:31], v[60:63], v[64:67]
v_mfma_f32_16x16x32_bf16 v[68:71], v[44:47], v[60:63], v[68:71]
ds_read_b64_tr_b16 v[24:25], v9 offset:24576
ds_read_b64_tr_b16 v[26:27], v9 offset:25088
ds_read_b128 v[56:59], v10 offset:384
ds_read_b64_tr_b16 v[40:41], v14 offset:24576
ds_read_b64_tr_b16 v[42:43], v14 offset:25088
s_waitcnt lgkmcnt(10)
v_mfma_f32_16x16x32_bf16 v[64:67], v[16:19], v[48:51], v[64:67]
v_mfma_f32_16x16x32_bf16 v[68:71], v[32:35], v[48:51], v[68:71]
ds_read_b64_tr_b16 v[28:29], v9 offset:28672
ds_read_b64_tr_b16 v[30:31], v9 offset:29184
ds_read_b128 v[60:63], v10 offset:448
ds_read_b64_tr_b16 v[44:45], v14 offset:28672
ds_read_b64_tr_b16 v[46:47], v14 offset:29184
s_waitcnt lgkmcnt(10)
v_mfma_f32_16x16x32_bf16 v[64:67], v[20:23], v[52:55], v[64:67]
v_mfma_f32_16x16x32_bf16 v[68:71], v[36:39], v[52:55], v[68:71]
ds_read_b64_tr_b16 v[16:17], v9 offset:32768
ds_read_b64_tr_b16 v[18:19], v9 offset:33280
ds_read_b128 v[48:51], v10 offset:512
ds_read_b64_tr_b16 v[32:33], v14 offset:32768
ds_read_b64_tr_b16 v[34:35], v14 offset:33280
s_waitcnt lgkmcnt(10)
v_mfma_f32_16x16x32_bf16 v[64:67], v[24:27], v[56:59], v[64:67]
v_mfma_f32_16x16x32_bf16 v[68:71], v[40:43], v[56:59], v[68:71]
ds_read_b64_tr_b16 v[20:21], v9 offset:36864
ds_read_b64_tr_b16 v[22:23], v9 offset:37376
ds_read_b128 v[52:55], v10 offset:576
ds_read_b64_tr_b16 v[36:37], v14 offset:36864
ds_read_b64_tr_b16 v[38:39], v14 offset:37376
s_waitcnt lgkmcnt(10)
v_mfma_f32_16x16x32_bf16 v[64:67], v[28:31], v[60:63], v[64:67]
v_mfma_f32_16x16x32_bf16 v[68:71], v[44:47], v[60:63], v[68:71]
ds_read_b64_tr_b16 v[24:25], v9 offset:40960
ds_read_b64_tr_b16 v[26:27], v9 offset:41472
ds_read_b128 v[56:59], v10 offset:640
ds_read_b64_tr_b16 v[40:41], v14 offset:40960
ds_read_b64_tr_b16 v[42:43], v14 offset:41472
s_waitcnt lgkmcnt(10)
v_mfma_f32_16x16x32_bf16 v[64:67], v[16:19], v[48:51], v[64:67]
v_mfma_f32_16x16x32_bf16 v[68:71], v[32:35], v[48:51], v[68:71]
ds_read_b64_tr_b16 v[28:29], v9 offset:45056
ds_read_b64_tr_b16 v[30:31], v9 offset:45568
ds_read_b128 v[60:63], v10 offset:704
ds_read_b64_tr_b16 v[44:45], v14 offset:45056
ds_read_b64_tr_b16 v[46:47], v14 offset:45568
s_waitcnt lgkmcnt(10)
v_mfma_f32_16x16x32_bf16 v[64:67], v[20:23], v[52:55], v[64:67]
v_mfma_f32_16x16x32_bf16 v[68:71], v[36:39], v[52:55], v[68:71]
ds_read_b64_tr_b16 v[16:17], v9 offset:49152
ds_read_b64_tr_b16 v[18:19], v9 offset:49664
ds_read_b128 v[48:51], v10 offset:768
ds_read_b64_tr_b16 v[32:33], v14 offset:49152
ds_read_b64_tr_b16 v[34:35], v14 offset:49664
s_waitcnt lgkmcnt(10)
v_mfma_f32_16x16x32_bf16 v[64:67], v[24:27], v[56:59], v[64:67]
v_mfma_f32_16x16x32_bf16 v[68:71], v[40:43], v[56:59], v[68:71]
ds_read_b64_tr_b16 v[20:21], v9 offset:53248
ds_read_b64_tr_b16 v[22:23], v9 offset:53760
ds_read_b128 v[52:55], v10 offset:832
ds_read_b64_tr_b16 v[36:37], v14 offset:53248
ds_read_b64_tr_b16 v[38:39], v14 offset:53760
s_waitcnt lgkmcnt(10)
v_mfma_f32_16x16x32_bf16 v[64:67], v[28:31], v[60:63], v[64:67]
v_mfma_f32_16x16x32_bf16 v[68:71], v[44:47], v[60:63], v[68:71]
ds_read_b64_tr_b16 v[24:25], v9 offset:57344
ds_read_b64_tr_b16 v[26:27], v9 offset:57856
ds_read_b128 v[56:59], v10 offset:896
ds_read_b64_tr_b16 v[40:41], v14 offset:57344
ds_read_b64_tr_b16 v[42:43], v14 offset:57856
s_waitcnt lgkmcnt(10)
v_mfma_f32_16x16x32_bf16 v[64:67], v[16:19], v[48:51], v[64:67]
v_mfma_f32_16x16x32_bf16 v[68:71], v[32:35], v[48:51], v[68:71]
ds_read_b64_tr_b16 v[28:29], v9 offset:61440
ds_read_b64_tr_b16 v[30:31], v9 offset:61952
ds_read_b128 v[60:63], v10 offset:960
ds_read_b64_tr_b16 v[44:45], v14 offset:61440
ds_read_b64_tr_b16 v[46:47], v14 offset:61952
s_waitcnt lgkmcnt(10)
v_mfma_f32_16x16x32_bf16 v[64:67], v[20:23], v[52:55], v[64:67]
v_mfma_f32_16x16x32_bf16 v[68:71], v[36:39], v[52:55], v[68:71]
s_waitcnt lgkmcnt(5)
v_mfma_f32_16x16x32_bf16 v[64:67], v[24:27], v[56:59], v[64:67]
v_mfma_f32_16x16x32_bf16 v[68:71], v[40:43], v[56:59], v[68:71]
s_waitcnt lgkmcnt(0)
v_mfma_f32_16x16x32_bf16 v[64:67], v[28:31], v[60:63], v[64:67]
v_mfma_f32_16x16x32_bf16 v[68:71], v[44:47], v[60:63], v[68:71]
s_nop 7
v_cvt_pk_bf16_f32 v64, v64, v64
v_and_b32 v64, 0xffff0000, v64
v_cvt_pk_bf16_f32 v68, v68, v68
v_and_b32 v68, 0xffff0000, v68
v_cvt_pk_bf16_f32 v65, v65, v65
v_and_b32 v65, 0xffff0000, v65
v_cvt_pk_bf16_f32 v69, v69, v69
v_and_b32 v69, 0xffff0000, v69
v_cvt_pk_bf16_f32 v66, v66, v66
v_and_b32 v66, 0xffff0000, v66
v_cvt_pk_bf16_f32 v70, v70, v70
v_and_b32 v70, 0xffff0000, v70
v_cvt_pk_bf16_f32 v67, v67, v67
v_and_b32 v67, 0xffff0000, v67
v_cvt_pk_bf16_f32 v71, v71, v71
v_and_b32 v71, 0xffff0000, v71
v_mul_f32 v72, 0xbfb8aa3b, v64
v_mul_f32 v73, 0xbfb8aa3b, v65
v_mul_f32 v74, 0xbfb8aa3b, v66
v_mul_f32 v75, 0xbfb8aa3b, v67
v_exp_f32 v72, v72
v_exp_f32 v73, v73
v_exp_f32 v74, v74
v_exp_f32 v75, v75
v_add_f32 v72, 1.0, v72
v_add_f32 v73, 1.0, v73
v_add_f32 v74, 1.0, v74
v_add_f32 v75, 1.0, v75
v_rcp_f32 v72, v72
v_rcp_f32 v73, v73
v_rcp_f32 v74, v74
v_rcp_f32 v75, v75
s_nop 0
v_mul_f32 v64, v64, v72
v_mul_f32 v65, v65, v73
v_mul_f32 v66, v66, v74
v_mul_f32 v67, v67, v75
v_cvt_pk_bf16_f32 v64, v64, v64
v_and_b32 v64, 0xffff0000, v64
v_cvt_pk_bf16_f32 v65, v65, v65
v_and_b32 v65, 0xffff0000, v65
v_cvt_pk_bf16_f32 v66, v66, v66
v_and_b32 v66, 0xffff0000, v66
v_cvt_pk_bf16_f32 v67, v67, v67
v_and_b32 v67, 0xffff0000, v67
v_mul_f32 v64, v64, v68
v_mul_f32 v65, v65, v69
v_mul_f32 v66, v66, v70
v_mul_f32 v67, v67, v71
v_cvt_pk_bf16_f32 v72, v64, v65
v_cvt_pk_bf16_f32 v73, v66, v67
s_mov_b32 exec_lo, 0x00ff00ff
s_mov_b32 exec_hi, 0x00ff00ff
ds_write_b64 v11, v[72:73]
s_mov_b64 exec, -1
v_mov_b32 v12, 8168
v_mov_b32 v13, 1
s_mov_b64 s[34:35], exec
s_mov_b32 exec_lo, 1
s_mov_b32 exec_hi, 0
s_waitcnt lgkmcnt(0)
ds_add_u32 v12, v13
s_mov_b64 exec, s[34:35]
s_add_u32 s22, s22, 8
s_endpgm
L_moe_d:
s_sub_u32 s22, s22, 4
s_waitcnt lgkmcnt(0)
s_mov_b32 s8, s6
s_mov_b32 s9, s7
s_mov_b32 s10, 0x900000
s_mov_b32 s11, 0x20000
s_lshl_b32 s26, s22, 3
s_add_u32 s26, s26, 0x80e000
s_buffer_load_dwordx2 s[82:83], s[8:11], s26
s_mov_b32 s12, s84
s_mov_b32 s13, s85
s_mov_b32 s14, 0x200000
s_mov_b32 s15, 0x20000
s_mov_b32 s72, s92
s_mov_b32 s73, s93
s_mov_b32 s74, 0x1c0000
s_mov_b32 s75, 0x20000
v_lshlrev_b32 v8, 4, v1
v_mov_b32 v9, 0
s_waitcnt lgkmcnt(0)
s_lshl_b32 s26, s82, 10
buffer_load_dwordx4 v[16:19], v8, s[12:15], s26 offen
s_lshl_b32 s27, s82, 4
s_add_u32 s27, s27, 0x800000
buffer_load_dwordx2 v[24:25], v9, s[8:11], s27 offen
s_lshl_b32 s26, s83, 10
buffer_load_dwordx4 v[20:23], v8, s[12:15], s26 offen
s_lshl_b32 s27, s83, 4
s_add_u32 s27, s27, 0x800000
buffer_load_dwordx2 v[26:27], v9, s[8:11], s27 offen
v_mov_b32 v12, 8172
v_mov_b32 v13, 1
s_mov_b64 s[34:35], exec
s_mov_b32 exec_lo, 1
s_mov_b32 exec_hi, 0
s_waitcnt lgkmcnt(0)
ds_add_u32 v12, v13
s_mov_b64 exec, s[34:35]
s_mul_i32 s28, s22, 6
s_add_u32 s28, s28, 40
v_lshrrev_b32 v4, 3, v1
v_and_b32 v5, 7, v1
v_bfe_u32 v6, v4, 1, 1
v_lshlrev_b32 v6, 1, v6
v_xor_b32 v5, v5, v6
v_mul_u32_u24 v4, 0xe00, v4
v_xor_b32 v6, 4, v5
v_lshl_add_u32 v7, v6, 4, v4
v_lshl_add_u32 v4, v5, 4, v4
v_add_u32 v7, 28672, v7
s_mov_b32 s18, 0x1c0000
s_mov_b32 s19, 0x20000
s_add_u32 s29, s28, 6
L_moe_dma_d:
s_cmp_lt_u32 s28, 32
s_cselect_b32 s16, s88, s90
s_cselect_b32 s17, s89, s91
s_and_b32 s82, s28, 31
s_mul_i32 s82, s82, 57344
s_lshl_b32 s83, s2, 7
s_add_u32 s82, s82, s83
s_lshl_b32 s83, s28, 11
s_add_u32 m0, s83, 32768
s_add_u32 s28, s28, 1
buffer_load_dwordx4 v4, s[16:19], s82 offen lds
s_add_u32 m0, m0, 1024
s_cmp_lt_u32 s28, s29
buffer_load_dwordx4 v7, s[16:19], s82 offen lds
s_cbranch_scc1 L_moe_dma_d
s_waitcnt vmcnt(12)
v_lshlrev_b32 v92, 16, v16
v_and_b32 v93, 0xffff0000, v16
v_lshlrev_b32 v94, 16, v17
v_and_b32 v95, 0xffff0000, v17
v_lshlrev_b32 v96, 16, v18
v_and_b32 v97, 0xffff0000, v18
v_lshlrev_b32 v98, 16, v19
v_and_b32 v99, 0xffff0000, v19
v_sub_f32 v92, v92, v24
v_sub_f32 v93, v93, v24
v_sub_f32 v94, v94, v24
v_sub_f32 v95, v95, v24
v_sub_f32 v96, v96, v24
v_sub_f32 v97, v97, v24
v_sub_f32 v98, v98, v24
v_sub_f32 v99, v99, v24
v_cvt_pk_bf16_f32 v16, v92, v93
v_cvt_pk_bf16_f32 v17, v94, v95
v_cvt_pk_bf16_f32 v18, v96, v97
v_cvt_pk_bf16_f32 v19, v98, v99
v_lshlrev_b32 v92, 16, v16
v_and_b32 v93, 0xffff0000, v16
v_lshlrev_b32 v94, 16, v17
v_and_b32 v95, 0xffff0000, v17
v_lshlrev_b32 v96, 16, v18
v_and_b32 v97, 0xffff0000, v18
v_lshlrev_b32 v98, 16, v19
v_and_b32 v99, 0xffff0000, v19
v_mul_f32 v92, v92, v25
v_mul_f32 v93, v93, v25
v_mul_f32 v94, v94, v25
v_mul_f32 v95, v95, v25
v_mul_f32 v96, v96, v25
v_mul_f32 v97, v97, v25
v_mul_f32 v98, v98, v25
v_mul_f32 v99, v99, v25
v_cvt_pk_bf16_f32 v16, v92, v93
v_cvt_pk_bf16_f32 v17, v94, v95
v_cvt_pk_bf16_f32 v18, v96, v97
v_cvt_pk_bf16_f32 v19, v98, v99
v_lshlrev_b32 v92, 16, v20
v_and_b32 v93, 0xffff0000, v20
v_lshlrev_b32 v94, 16, v21
v_and_b32 v95, 0xffff0000, v21
v_lshlrev_b32 v96, 16, v22
v_and_b32 v97, 0xffff0000, v22
v_lshlrev_b32 v98, 16, v23
v_and_b32 v99, 0xffff0000, v23
v_sub_f32 v92, v92, v26
v_sub_f32 v93, v93, v26
v_sub_f32 v94, v94, v26
v_sub_f32 v95, v95, v26
v_sub_f32 v96, v96, v26
v_sub_f32 v97, v97, v26
v_sub_f32 v98, v98, v26
v_sub_f32 v99, v99, v26
v_cvt_pk_bf16_f32 v20, v92, v93
v_cvt_pk_bf16_f32 v21, v94, v95
v_cvt_pk_bf16_f32 v22, v96, v97
v_cvt_pk_bf16_f32 v23, v98, v99
v_lshlrev_b32 v92, 16, v20
v_and_b32 v93, 0xffff0000, v20
v_lshlrev_b32 v94, 16, v21
v_and_b32 v95, 0xffff0000, v21
v_lshlrev_b32 v96, 16, v22
v_and_b32 v97, 0xffff0000, v22
v_lshlrev_b32 v98, 16, v23
v_and_b32 v99, 0xffff0000, v23
v_mul_f32 v92, v92, v27
v_mul_f32 v93, v93, v27
v_mul_f32 v94, v94, v27
v_mul_f32 v95, v95, v27
v_mul_f32 v96, v96, v27
v_mul_f32 v97, v97, v27
v_mul_f32 v98, v98, v27
v_mul_f32 v99, v99, v27
v_cvt_pk_bf16_f32 v20, v92, v93
v_cvt_pk_bf16_f32 v21, v94, v95
v_cvt_pk_bf16_f32 v22, v96, v97
v_cvt_pk_bf16_f32 v23, v98, v99
s_lshr_b32 s82, s22, 1
s_mul_i32 s82, s82, 16512
s_and_b32 s83, s22, 1
s_mul_i32 s83, s83, 2112
s_add_u32 s82, s82, s83
v_add_u32 v10, s82, v8
ds_write_b128 v10, v[16:19]
ds_write_b128 v10, v[20:23] offset:1056
s_waitcnt vmcnt(0)
v_mov_b32 v12, 8164
v_mov_b32 v13, 1
s_mov_b64 s[34:35], exec
s_mov_b32 exec_lo, 1
s_mov_b32 exec_hi, 0
s_waitcnt lgkmcnt(0)
ds_add_u32 v12, v13
s_mov_b64 exec, s[34:35]
v_lshrrev_b32 v5, 4, v1
v_and_b32 v6, 15, v1
v_lshlrev_b32 v5, 13, v5
v_lshl_add_u32 v5, v6, 4, v5
s_lshl_b32 s94, s2, 16
s_lshl_b32 s95, s22, 8
s_add_u32 s32, s94, s95
s_add_u32 s83, s32, 0
buffer_load_dwordx4 v[28:31], v5, s[72:75], s83 offen offset:0
s_add_u32 s83, s32, 0
buffer_load_dwordx4 v[32:35], v5, s[72:75], s83 offen offset:1024
s_add_u32 s83, s32, 0
buffer_load_dwordx4 v[36:39], v5, s[72:75], s83 offen offset:2048
s_add_u32 s83, s32, 0
buffer_load_dwordx4 v[40:43], v5, s[72:75], s83 offen offset:3072
s_add_u32 s83, s32, 4096
buffer_load_dwordx4 v[44:47], v5, s[72:75], s83 offen offset:0
s_add_u32 s83, s32, 4096
buffer_load_dwordx4 v[48:51], v5, s[72:75], s83 offen offset:1024
s_add_u32 s83, s32, 4096
buffer_load_dwordx4 v[52:55], v5, s[72:75], s83 offen offset:2048
s_add_u32 s83, s32, 4096
buffer_load_dwordx4 v[56:59], v5, s[72:75], s83 offen offset:3072
s_add_u32 s83, s32, 32768
buffer_load_dwordx4 v[60:63], v5, s[72:75], s83 offen offset:0
s_add_u32 s83, s32, 32768
buffer_load_dwordx4 v[64:67], v5, s[72:75], s83 offen offset:1024
s_add_u32 s83, s32, 32768
buffer_load_dwordx4 v[68:71], v5, s[72:75], s83 offen offset:2048
s_add_u32 s83, s32, 32768
buffer_load_dwordx4 v[72:75], v5, s[72:75], s83 offen offset:3072
s_add_u32 s83, s32, 36864
buffer_load_dwordx4 v[76:79], v5, s[72:75], s83 offen offset:0
s_add_u32 s83, s32, 36864
buffer_load_dwordx4 v[80:83], v5, s[72:75], s83 offen offset:1024
s_add_u32 s83, s32, 36864
buffer_load_dwordx4 v[84:87], v5, s[72:75], s83 offen offset:2048
s_add_u32 s83, s32, 36864
buffer_load_dwordx4 v[88:91], v5, s[72:75], s83 offen offset:3072
s_mov_b32 s94, 0x05040100
s_mov_b32 s95, 0x07060302
v_and_b32 v10, 7, v1
v_lshrrev_b32 v9, 4, v1
v_lshlrev_b32 v10, 7, v10
v_lshl_add_u32 v10, v9, 4, v10
v_add_u32 v10, 4224, v10
v_and_b32 v11, 15, v1
v_lshlrev_b32 v11, 11, v11
v_lshl_add_u32 v11, v9, 4, v11
s_lshl_b32 s82, s2, 14
s_lshl_b32 s83, s22, 9
s_add_u32 s82, s82, s83
s_add_u32 s82, s82, 0x810000
s_waitcnt vmcnt(8)
v_perm_b32 v92, v32, v28, s94
v_perm_b32 v93, v40, v36, s94
v_perm_b32 v94, v48, v44, s94
v_perm_b32 v95, v56, v52, s94
v_perm_b32 v96, v32, v28, s95
v_perm_b32 v97, v40, v36, s95
v_perm_b32 v98, v48, v44, s95
v_perm_b32 v99, v56, v52, s95
v_perm_b32 v100, v33, v29, s94
v_perm_b32 v101, v41, v37, s94
v_perm_b32 v102, v49, v45, s94
v_perm_b32 v103, v57, v53, s94
v_perm_b32 v104, v33, v29, s95
v_perm_b32 v105, v41, v37, s95
v_perm_b32 v106, v49, v45, s95
v_perm_b32 v107, v57, v53, s95
v_perm_b32 v108, v34, v30, s94
v_perm_b32 v109, v42, v38, s94
v_perm_b32 v110, v50, v46, s94
v_perm_b32 v111, v58, v54, s94
v_perm_b32 v112, v34, v30, s95
v_perm_b32 v113, v42, v38, s95
v_perm_b32 v114, v50, v46, s95
v_perm_b32 v115, v58, v54, s95
v_perm_b32 v116, v35, v31, s94
v_perm_b32 v117, v43, v39, s94
v_perm_b32 v118, v51, v47, s94
v_perm_b32 v119, v59, v55, s94
v_perm_b32 v120, v35, v31, s95
v_perm_b32 v121, v43, v39, s95
v_perm_b32 v122, v51, v47, s95
v_perm_b32 v123, v59, v55, s95
s_waitcnt vmcnt(0)
v_perm_b32 v28, v64, v60, s94
v_perm_b32 v29, v72, v68, s94
v_perm_b32 v30, v80, v76, s94
v_perm_b32 v31, v88, v84, s94
v_perm_b32 v32, v64, v60, s95
v_perm_b32 v33, v72, v68, s95
v_perm_b32 v34, v80, v76, s95
v_perm_b32 v35, v88, v84, s95
v_perm_b32 v36, v65, v61, s94
v_perm_b32 v37, v73, v69, s94
v_perm_b32 v38, v81, v77, s94
v_perm_b32 v39, v89, v85, s94
v_perm_b32 v40, v65, v61, s95
v_perm_b32 v41, v73, v69, s95
v_perm_b32 v42, v81, v77, s95
v_perm_b32 v43, v89, v85, s95
v_perm_b32 v44, v66, v62, s94
v_perm_b32 v45, v74, v70, s94
v_perm_b32 v46, v82, v78, s94
v_perm_b32 v47, v90, v86, s94
v_perm_b32 v48, v66, v62, s95
v_perm_b32 v49, v74, v70, s95
v_perm_b32 v50, v82, v78, s95
v_perm_b32 v51, v90, v86, s95
v_perm_b32 v52, v67, v63, s94
v_perm_b32 v53, v75, v71, s94
v_perm_b32 v54, v83, v79, s94
v_perm_b32 v55, v91, v87, s94
v_perm_b32 v56, v67, v63, s95
v_perm_b32 v57, v75, v71, s95
v_perm_b32 v58, v83, v79, s95
v_perm_b32 v59, v91, v87, s95
v_mov_b32 v12, 8168
s_mov_b32 s33, 0
L_sync_m2:
ds_read_b32 v13, v12
s_add_u32 s33, s33, 1
s_waitcnt lgkmcnt(0)
v_readfirstlane_b32 s36, v13
s_cmp_gt_u32 s33, 0x100000
s_cbranch_scc1 L_syncd_m2
s_cmp_ge_u32 s36, 4
s_cbranch_scc1 L_syncd_m2
s_sleep 1
s_branch L_sync_m2
L_syncd_m2:
ds_read_b128 v[16:19], v10
ds_read_b128 v[20:23], v10 offset:64
s_waitcnt lgkmcnt(1)
v_mfma_f32_16x16x32_bf16 v[60:63], v[92:95], v[16:19], 0
v_mfma_f32_16x16x32_bf16 v[64:67], v[96:99], v[16:19], 0
v_mfma_f32_16x16x32_bf16 v[68:71], v[100:103], v[16:19], 0
v_mfma_f32_16x16x32_bf16 v[72:75], v[104:107], v[16:19], 0
v_mfma_f32_16x16x32_bf16 v[76:79], v[108:111], v[16:19], 0
v_mfma_f32_16x16x32_bf16 v[80:83], v[112:115], v[16:19], 0
v_mfma_f32_16x16x32_bf16 v[84:87], v[116:119], v[16:19], 0
v_mfma_f32_16x16x32_bf16 v[88:91], v[120:123], v[16:19], 0
s_waitcnt lgkmcnt(0)
v_mfma_f32_16x16x32_bf16 v[60:63], v[28:31], v[20:23], v[60:63]
v_mfma_f32_16x16x32_bf16 v[64:67], v[32:35], v[20:23], v[64:67]
v_mfma_f32_16x16x32_bf16 v[68:71], v[36:39], v[20:23], v[68:71]
v_mfma_f32_16x16x32_bf16 v[72:75], v[40:43], v[20:23], v[72:75]
v_mfma_f32_16x16x32_bf16 v[76:79], v[44:47], v[20:23], v[76:79]
v_mfma_f32_16x16x32_bf16 v[80:83], v[48:51], v[20:23], v[80:83]
v_mfma_f32_16x16x32_bf16 v[84:87], v[52:55], v[20:23], v[84:87]
v_mfma_f32_16x16x32_bf16 v[88:91], v[56:59], v[20:23], v[88:91]
s_mov_b32 exec_lo, 0x00ff00ff
s_mov_b32 exec_hi, 0x00ff00ff
s_nop 0
buffer_store_dwordx4 v[60:63], v11, s[8:11], s82 offen offset:0
buffer_store_dwordx4 v[64:67], v11, s[8:11], s82 offen offset:64
buffer_store_dwordx4 v[68:71], v11, s[8:11], s82 offen offset:128
buffer_store_dwordx4 v[72:75], v11, s[8:11], s82 offen offset:192
buffer_store_dwordx4 v[76:79], v11, s[8:11], s82 offen offset:256
buffer_store_dwordx4 v[80:83], v11, s[8:11], s82 offen offset:320
buffer_store_dwordx4 v[84:87], v11, s[8:11], s82 offen offset:384
s_nop 4
buffer_store_dwordx4 v[88:91], v11, s[8:11], s82 offen offset:448
s_add_u32 s22, s22, 12
s_endpgm
L_k2_end:
s_endpgm
.globl k3_kernel
.p2align 8
.type k3_kernel,@function
k3_kernel:

s_cmp_ge_u32 s2, 256
s_cbranch_scc1 L_k3_end
s_load_dwordx2 s[4:5], s[0:1], 0
s_load_dwordx2 s[6:7], s[0:1], 16
s_load_dwordx4 s[24:27], s[0:1], 64
s_load_dwordx2 s[38:39], s[0:1], 80
s_and_b32 s33, s2, 7
s_lshr_b32 s34, s2, 3
s_lshl_b32 s28, s33, 2
s_and_b32 s29, s34, 3
s_add_u32 s28, s28, s29
s_lshr_b32 s29, s34, 2
v_lshrrev_b32 v2, 6, v0
v_and_b32 v1, 63, v0
v_readfirstlane_b32 s30, v2
s_cmp_ge_u32 s30, 4
s_cbranch_scc0 L_k3_cons
v_lshlrev_b32 v4, 4, v1
v_lshrrev_b32 v2, 3, v1
v_and_b32 v3, 7, v1
v_bfe_u32 v9, v1, 4, 1
v_lshlrev_b32 v9, 2, v9
v_xor_b32 v3, v3, v9
v_lshlrev_b32 v3, 4, v3
v_lshl_add_u32 v5, v2, 10, v3
s_sub_u32 s30, s30, 4
s_and_b32 s31, s30, 1
s_lshr_b32 s32, s30, 1
s_lshl_b32 s68, s28, 1
s_add_u32 s68, s68, s31
s_lshl_b32 s68, s68, 10
s_lshl_b32 s69, s32, 17
s_add_u32 s68, s68, s69
s_add_u32 s68, s68, 0x0
s_lshl_b32 s70, s31, 15
s_lshl_b32 s69, s32, 11
s_add_u32 s70, s70, s69
s_lshl_b32 s71, s30, 14
s_lshl_b32 s69, s29, 7
s_add_u32 s71, s71, s69
s_lshl_b32 s72, s30, 11
s_add_u32 s72, s72, 65536
s_waitcnt lgkmcnt(0)
s_mov_b32 s8, s38
s_mov_b32 s9, s39
s_mov_b32 s10, 0x900000
s_mov_b32 s11, 0x20000
s_mov_b32 s16, s6
s_mov_b32 s17, s7
s_mov_b32 s18, 0x80000
s_mov_b32 s19, 0x20000
s_add_u32 s62, s38, 0x80e000
s_addc_u32 s63, s39, 0
s_load_dwordx16 s[40:55], s[62:63], 0
s_mov_b32 m0, s72
s_add_u32 s69, s71, 8192
buffer_load_dwordx4 v5, s[16:19], s71 offen lds
s_add_u32 m0, m0, 1024
s_add_u32 s71, s71, 131072
buffer_load_dwordx4 v5, s[16:19], s69 offen lds
s_mov_b32 m0, s70
s_add_u32 s69, s68, 0x10000
buffer_load_dwordx4 v4, s[8:11], s68 offen lds
s_add_u32 m0, m0, 1024
s_add_u32 s68, s68, 0x80000
buffer_load_dwordx4 v4, s[8:11], s69 offen lds
s_add_u32 s70, s70, 8192
s_add_u32 s72, s72, 16384
s_mov_b32 m0, s72
s_add_u32 s69, s71, 8192
buffer_load_dwordx4 v5, s[16:19], s71 offen lds
s_add_u32 m0, m0, 1024
s_add_u32 s71, s71, 131072
buffer_load_dwordx4 v5, s[16:19], s69 offen lds
s_mov_b32 m0, s70
s_add_u32 s69, s68, 0x10000
buffer_load_dwordx4 v4, s[8:11], s68 offen lds
s_add_u32 m0, m0, 1024
s_add_u32 s68, s68, 0x80000
buffer_load_dwordx4 v4, s[8:11], s69 offen lds
s_add_u32 s70, s70, 8192
s_add_u32 s72, s72, 16384
v_lshrrev_b32 v12, 4, v1
v_and_b32 v13, 15, v1
v_lshlrev_b32 v12, 14, v12
v_lshrrev_b32 v14, 1, v13
v_lshl_add_u32 v12, v14, 6, v12
v_and_b32 v15, 1, v13
v_lshl_add_u32 v12, v15, 4, v12
s_lshr_b32 s33, s29, 1
s_lshl_b32 s33, s33, 9
s_and_b32 s34, s29, 1
s_lshl_b32 s34, s34, 5
s_add_u32 s33, s33, s34
s_lshl_b32 s34, s30, 11
s_add_u32 s73, s33, s34
s_add_u32 s73, s73, 0x810000
v_lshl_add_u32 v14, v15, 5, v14
s_lshl_b32 s34, s30, 8
s_add_u32 s34, s34, 131072
v_lshl_add_u32 v14, v14, 2, s34
s_mov_b32 m0, s30
s_waitcnt lgkmcnt(0)
s_movrels_b32 s59, s40
s_movrels_b32 s60, s48
s_lshr_b32 s34, s59, 6
s_waitcnt vmcnt(4)
s_barrier
s_cmp_eq_u32 s34, s28
s_cbranch_scc1 L_k3_tok
s_mov_b32 m0, s72
s_add_u32 s69, s71, 8192
buffer_load_dwordx4 v5, s[16:19], s71 offen lds
s_add_u32 m0, m0, 1024
s_add_u32 s71, s71, 131072
buffer_load_dwordx4 v5, s[16:19], s69 offen lds
s_mov_b32 m0, s70
s_add_u32 s69, s68, 0x10000
buffer_load_dwordx4 v4, s[8:11], s68 offen lds
s_add_u32 m0, m0, 1024
s_add_u32 s68, s68, 0x80000
buffer_load_dwordx4 v4, s[8:11], s69 offen lds
s_add_u32 s70, s70, 8192
s_add_u32 s72, s72, 16384
s_waitcnt vmcnt(4)
s_barrier
s_mov_b32 m0, s72
s_add_u32 s69, s71, 8192
buffer_load_dwordx4 v5, s[16:19], s71 offen lds
s_add_u32 m0, m0, 1024
s_add_u32 s71, s71, 131072
buffer_load_dwordx4 v5, s[16:19], s69 offen lds
s_mov_b32 m0, s70
s_add_u32 s69, s68, 0x10000
buffer_load_dwordx4 v4, s[8:11], s68 offen lds
s_add_u32 m0, m0, 1024
s_add_u32 s68, s68, 0x80000
buffer_load_dwordx4 v4, s[8:11], s69 offen lds
s_add_u32 s70, s70, 8192
s_add_u32 s72, s72, 16384
s_waitcnt vmcnt(4)
s_barrier
s_branch L_k3_ldfin
L_k3_tok:
buffer_load_dwordx4 v[64:67], v12, s[8:11], s73 offen
s_add_u32 s73, s73, 0x10000
buffer_load_dwordx4 v[68:71], v12, s[8:11], s73 offen
s_add_u32 s73, s73, 0x10000
buffer_load_dwordx4 v[72:75], v12, s[8:11], s73 offen
s_add_u32 s73, s73, 0x10000
buffer_load_dwordx4 v[76:79], v12, s[8:11], s73 offen
s_add_u32 s73, s73, 0x10000
buffer_load_dwordx4 v[80:83], v12, s[8:11], s73 offen
s_add_u32 s73, s73, 0x10000
buffer_load_dwordx4 v[84:87], v12, s[8:11], s73 offen
s_add_u32 s73, s73, 0x10000
buffer_load_dwordx4 v[88:91], v12, s[8:11], s73 offen
s_add_u32 s73, s73, 0x10000
s_mov_b32 m0, s72
s_add_u32 s69, s71, 8192
buffer_load_dwordx4 v5, s[16:19], s71 offen lds
s_add_u32 m0, m0, 1024
s_add_u32 s71, s71, 131072
buffer_load_dwordx4 v5, s[16:19], s69 offen lds
s_mov_b32 m0, s70
s_add_u32 s69, s68, 0x10000
buffer_load_dwordx4 v4, s[8:11], s68 offen lds
s_add_u32 m0, m0, 1024
s_add_u32 s68, s68, 0x80000
buffer_load_dwordx4 v4, s[8:11], s69 offen lds
s_add_u32 s70, s70, 8192
s_add_u32 s72, s72, 16384
s_waitcnt vmcnt(11)
s_barrier
s_mov_b32 m0, s72
s_add_u32 s69, s71, 8192
buffer_load_dwordx4 v5, s[16:19], s71 offen lds
s_add_u32 m0, m0, 1024
s_add_u32 s71, s71, 131072
buffer_load_dwordx4 v5, s[16:19], s69 offen lds
s_mov_b32 m0, s70
s_add_u32 s69, s68, 0x10000
buffer_load_dwordx4 v4, s[8:11], s68 offen lds
s_add_u32 m0, m0, 1024
s_add_u32 s68, s68, 0x80000
buffer_load_dwordx4 v4, s[8:11], s69 offen lds
s_add_u32 s70, s70, 8192
s_add_u32 s72, s72, 16384
s_waitcnt vmcnt(4)
s_barrier
v_pk_add_f32 v[64:65], v[64:65], v[68:69]
v_pk_add_f32 v[66:67], v[66:67], v[70:71]
v_pk_add_f32 v[72:73], v[72:73], v[76:77]
v_pk_add_f32 v[74:75], v[74:75], v[78:79]
v_pk_add_f32 v[80:81], v[80:81], v[84:85]
v_pk_add_f32 v[82:83], v[82:83], v[86:87]
v_pk_add_f32 v[64:65], v[64:65], v[72:73]
v_pk_add_f32 v[66:67], v[66:67], v[74:75]
v_pk_add_f32 v[80:81], v[80:81], v[88:89]
v_pk_add_f32 v[82:83], v[82:83], v[90:91]
v_pk_add_f32 v[64:65], v[64:65], v[80:81]
v_pk_add_f32 v[66:67], v[66:67], v[82:83]
v_mov_b32 v68, v64
v_mov_b32 v69, v65
v_mov_b32 v70, v66
v_mov_b32 v71, v67
s_nop 1
v_permlane16_swap_b32 v64, v68
v_permlane16_swap_b32 v65, v69
v_permlane16_swap_b32 v66, v70
v_permlane16_swap_b32 v67, v71
s_nop 0
v_add_f32 v64, v64, v68
v_add_f32 v65, v65, v69
v_add_f32 v66, v66, v70
v_add_f32 v67, v67, v71
v_mov_b32 v68, v64
v_mov_b32 v69, v65
v_mov_b32 v70, v66
v_mov_b32 v71, v67
s_nop 1
v_permlane32_swap_b32 v64, v68
v_permlane32_swap_b32 v65, v69
v_permlane32_swap_b32 v66, v70
v_permlane32_swap_b32 v67, v71
s_nop 0
v_add_f32 v64, v64, v68
v_add_f32 v65, v65, v69
v_add_f32 v66, v66, v70
v_add_f32 v67, v67, v71
v_cvt_pk_bf16_f32 v64, v64, v64
v_and_b32 v64, 0xffff0000, v64
v_mul_f32 v64, s60, v64
v_cvt_pk_bf16_f32 v64, v64, v64
v_and_b32 v64, 0xffff0000, v64
v_cvt_pk_bf16_f32 v65, v65, v65
v_and_b32 v65, 0xffff0000, v65
v_mul_f32 v65, s60, v65
v_cvt_pk_bf16_f32 v65, v65, v65
v_and_b32 v65, 0xffff0000, v65
v_cvt_pk_bf16_f32 v66, v66, v66
v_and_b32 v66, 0xffff0000, v66
v_mul_f32 v66, s60, v66
v_cvt_pk_bf16_f32 v66, v66, v66
v_and_b32 v66, 0xffff0000, v66
v_cvt_pk_bf16_f32 v67, v67, v67
v_and_b32 v67, 0xffff0000, v67
v_mul_f32 v67, s60, v67
v_cvt_pk_bf16_f32 v67, v67, v67
v_and_b32 v67, 0xffff0000, v67
ds_write_b32 v14, v64 offset:0
ds_write_b32 v14, v65 offset:32
ds_write_b32 v14, v66 offset:64
ds_write_b32 v14, v67 offset:96
L_k3_ldfin:
s_waitcnt vmcnt(0) lgkmcnt(0)
s_barrier
s_add_u32 s30, s30, 4
s_endpgm
L_k3_cons:
s_and_b32 s31, s30, 1
s_lshr_b32 s32, s30, 1
s_lshl_b32 s36, s28, 1
s_add_u32 s36, s36, s31
v_and_b32 v2, 31, v1
v_lshrrev_b32 v3, 5, v1
s_lshl_b32 s33, s36, 5
v_add_u32 v9, s33, v2
v_lshlrev_b32 v8, 10, v9
v_lshl_add_u32 v8, v3, 4, v8
s_lshl_b32 s33, s29, 7
s_lshl_b32 s34, s32, 6
s_add_u32 s33, s33, s34
v_add_u32 v8, s33, v8
v_lshlrev_b32 v9, 4, v9
s_waitcnt lgkmcnt(0)
s_mov_b32 s8, s38
s_mov_b32 s9, s39
s_mov_b32 s10, 0x900000
s_mov_b32 s11, 0x20000
s_mov_b32 s12, s4
s_mov_b32 s13, s5
s_mov_b32 s14, 0x200000
s_mov_b32 s15, 0x20000
s_add_u32 s62, s38, 0x80e000
s_addc_u32 s63, s39, 0
s_load_dwordx16 s[40:55], s[62:63], 0
buffer_load_dwordx4 v[32:35], v8, s[12:15], 0 offen
buffer_load_dwordx4 v[36:39], v8, s[12:15], 0 offen offset:32
s_mov_b32 s33, 0x800000
buffer_load_dwordx2 v[10:11], v9, s[8:11], s33 offen
s_mov_b32 s20, s24
s_mov_b32 s21, s25
s_mov_b32 s22, 0x200000
s_mov_b32 s23, 0x20000
s_lshl_b32 s33, s31, 15
v_lshl_add_u32 v6, v1, 4, s33
v_bfe_u32 v12, v1, 2, 2
v_lshl_add_u32 v13, v3, 2, v12
v_lshlrev_b32 v13, 7, v13
v_lshrrev_b32 v12, 1, v12
v_xor_b32 v12, s32, v12
v_lshl_add_u32 v13, v12, 6, v13
v_bfe_u32 v12, v1, 4, 1
v_lshl_add_u32 v13, v12, 5, v13
v_and_b32 v12, 3, v1
v_lshl_add_u32 v13, v12, 3, v13
v_add_u32 v7, 0x10000, v13
v_mov_b32 v16, 0
v_mov_b32 v17, 0
v_mov_b32 v18, 0
v_mov_b32 v19, 0
v_mov_b32 v20, 0
v_mov_b32 v21, 0
v_mov_b32 v22, 0
v_mov_b32 v23, 0
v_mov_b32 v24, 0
v_mov_b32 v25, 0
v_mov_b32 v26, 0
v_mov_b32 v27, 0
v_mov_b32 v28, 0
v_mov_b32 v29, 0
v_mov_b32 v30, 0
v_mov_b32 v31, 0
s_waitcnt vmcnt(0) lgkmcnt(0)
v_lshlrev_b32 v40, 16, v32
v_and_b32 v41, 0xffff0000, v32
v_lshlrev_b32 v42, 16, v33
v_and_b32 v43, 0xffff0000, v33
v_lshlrev_b32 v44, 16, v34
v_and_b32 v45, 0xffff0000, v34
v_lshlrev_b32 v46, 16, v35
v_and_b32 v47, 0xffff0000, v35
v_lshlrev_b32 v48, 16, v36
v_and_b32 v49, 0xffff0000, v36
v_lshlrev_b32 v50, 16, v37
v_and_b32 v51, 0xffff0000, v37
v_lshlrev_b32 v52, 16, v38
v_and_b32 v53, 0xffff0000, v38
v_lshlrev_b32 v54, 16, v39
v_and_b32 v55, 0xffff0000, v39
v_sub_f32 v128, v40, v10
v_sub_f32 v129, v41, v10
v_sub_f32 v130, v42, v10
v_sub_f32 v131, v43, v10
v_sub_f32 v132, v44, v10
v_sub_f32 v133, v45, v10
v_sub_f32 v134, v46, v10
v_sub_f32 v135, v47, v10
v_sub_f32 v136, v48, v10
v_sub_f32 v137, v49, v10
v_sub_f32 v138, v50, v10
v_sub_f32 v139, v51, v10
v_sub_f32 v140, v52, v10
v_sub_f32 v141, v53, v10
v_sub_f32 v142, v54, v10
v_sub_f32 v143, v55, v10
v_cvt_pk_bf16_f32 v32, v128, v129
v_cvt_pk_bf16_f32 v33, v130, v131
v_cvt_pk_bf16_f32 v34, v132, v133
v_cvt_pk_bf16_f32 v35, v134, v135
v_cvt_pk_bf16_f32 v36, v136, v137
v_cvt_pk_bf16_f32 v37, v138, v139
v_cvt_pk_bf16_f32 v38, v140, v141
v_cvt_pk_bf16_f32 v39, v142, v143
v_lshlrev_b32 v128, 16, v32
v_and_b32 v129, 0xffff0000, v32
v_lshlrev_b32 v130, 16, v33
v_and_b32 v131, 0xffff0000, v33
v_lshlrev_b32 v132, 16, v34
v_and_b32 v133, 0xffff0000, v34
v_lshlrev_b32 v134, 16, v35
v_and_b32 v135, 0xffff0000, v35
v_lshlrev_b32 v136, 16, v36
v_and_b32 v137, 0xffff0000, v36
v_lshlrev_b32 v138, 16, v37
v_and_b32 v139, 0xffff0000, v37
v_lshlrev_b32 v140, 16, v38
v_and_b32 v141, 0xffff0000, v38
v_lshlrev_b32 v142, 16, v39
v_and_b32 v143, 0xffff0000, v39
v_mul_f32 v128, v128, v11
v_mul_f32 v129, v129, v11
v_mul_f32 v130, v130, v11
v_mul_f32 v131, v131, v11
v_mul_f32 v132, v132, v11
v_mul_f32 v133, v133, v11
v_mul_f32 v134, v134, v11
v_mul_f32 v135, v135, v11
v_mul_f32 v136, v136, v11
v_mul_f32 v137, v137, v11
v_mul_f32 v138, v138, v11
v_mul_f32 v139, v139, v11
v_mul_f32 v140, v140, v11
v_mul_f32 v141, v141, v11
v_mul_f32 v142, v142, v11
v_mul_f32 v143, v143, v11
v_cvt_pk_bf16_f32 v32, v128, v129
v_cvt_pk_bf16_f32 v33, v130, v131
v_cvt_pk_bf16_f32 v34, v132, v133
v_cvt_pk_bf16_f32 v35, v134, v135
v_cvt_pk_bf16_f32 v36, v136, v137
v_cvt_pk_bf16_f32 v37, v138, v139
v_cvt_pk_bf16_f32 v38, v140, v141
v_cvt_pk_bf16_f32 v39, v142, v143
v_lshlrev_b32 v128, 16, v32
v_and_b32 v129, 0xffff0000, v32
v_lshlrev_b32 v130, 16, v33
v_and_b32 v131, 0xffff0000, v33
v_lshlrev_b32 v132, 16, v34
v_and_b32 v133, 0xffff0000, v34
v_lshlrev_b32 v134, 16, v35
v_and_b32 v135, 0xffff0000, v35
v_lshlrev_b32 v136, 16, v36
v_and_b32 v137, 0xffff0000, v36
v_lshlrev_b32 v138, 16, v37
v_and_b32 v139, 0xffff0000, v37
v_lshlrev_b32 v140, 16, v38
v_and_b32 v141, 0xffff0000, v38
v_lshlrev_b32 v142, 16, v39
v_and_b32 v143, 0xffff0000, v39
v_add_f32 v40, v40, v128
v_add_f32 v41, v41, v129
v_add_f32 v42, v42, v130
v_add_f32 v43, v43, v131
v_add_f32 v44, v44, v132
v_add_f32 v45, v45, v133
v_add_f32 v46, v46, v134
v_add_f32 v47, v47, v135
v_add_f32 v48, v48, v136
v_add_f32 v49, v49, v137
v_add_f32 v50, v50, v138
v_add_f32 v51, v51, v139
v_add_f32 v52, v52, v140
v_add_f32 v53, v53, v141
v_add_f32 v54, v54, v142
v_add_f32 v55, v55, v143
s_mov_b32 s67, 0
s_lshr_b32 s34, s40, 5
s_cmp_eq_u32 s34, s36
s_cselect_b32 s34, 1, 0
s_or_b32 s67, s67, s34
s_lshr_b32 s34, s41, 5
s_cmp_eq_u32 s34, s36
s_cselect_b32 s34, 2, 0
s_or_b32 s67, s67, s34
s_lshr_b32 s34, s42, 5
s_cmp_eq_u32 s34, s36
s_cselect_b32 s34, 4, 0
s_or_b32 s67, s67, s34
s_lshr_b32 s34, s43, 5
s_cmp_eq_u32 s34, s36
s_cselect_b32 s34, 8, 0
s_or_b32 s67, s67, s34
s_lshr_b32 s34, s44, 5
s_cmp_eq_u32 s34, s36
s_cselect_b32 s34, 16, 0
s_or_b32 s67, s67, s34
s_lshr_b32 s34, s45, 5
s_cmp_eq_u32 s34, s36
s_cselect_b32 s34, 32, 0
s_or_b32 s67, s67, s34
s_lshr_b32 s34, s46, 5
s_cmp_eq_u32 s34, s36
s_cselect_b32 s34, 64, 0
s_or_b32 s67, s67, s34
s_lshr_b32 s34, s47, 5
s_cmp_eq_u32 s34, s36
s_cselect_b32 s34, 128, 0
s_or_b32 s67, s67, s34
s_mov_b32 s35, 0
L_k3_loop:
s_barrier
ds_read_b128 v[64:67], v6 offset:0
ds_read_b64_tr_b16 v[96:97], v7 offset:0
ds_read_b64_tr_b16 v[98:99], v7 offset:1024
ds_read_b128 v[68:71], v6 offset:1024
ds_read_b64_tr_b16 v[100:101], v7 offset:2048
ds_read_b64_tr_b16 v[102:103], v7 offset:3072
ds_read_b128 v[72:75], v6 offset:2048
ds_read_b64_tr_b16 v[104:105], v7 offset:4096
ds_read_b64_tr_b16 v[106:107], v7 offset:5120
ds_read_b128 v[76:79], v6 offset:3072
ds_read_b64_tr_b16 v[108:109], v7 offset:6144
ds_read_b64_tr_b16 v[110:111], v7 offset:7168
s_waitcnt lgkmcnt(9)
v_mfma_f32_32x32x16_bf16 v[16:31], v[96:99], v[64:67], v[16:31]
ds_read_b128 v[80:83], v6 offset:4096
ds_read_b64_tr_b16 v[112:113], v7 offset:8192
ds_read_b64_tr_b16 v[114:115], v7 offset:9216
s_waitcnt lgkmcnt(9)
v_mfma_f32_32x32x16_bf16 v[16:31], v[100:103], v[68:71], v[16:31]
ds_read_b128 v[84:87], v6 offset:5120
ds_read_b64_tr_b16 v[116:117], v7 offset:10240
ds_read_b64_tr_b16 v[118:119], v7 offset:11264
s_waitcnt lgkmcnt(9)
v_mfma_f32_32x32x16_bf16 v[16:31], v[104:107], v[72:75], v[16:31]
ds_read_b128 v[88:91], v6 offset:6144
ds_read_b64_tr_b16 v[120:121], v7 offset:12288
ds_read_b64_tr_b16 v[122:123], v7 offset:13312
s_waitcnt lgkmcnt(9)
v_mfma_f32_32x32x16_bf16 v[16:31], v[108:111], v[76:79], v[16:31]
ds_read_b128 v[92:95], v6 offset:7168
ds_read_b64_tr_b16 v[124:125], v7 offset:14336
ds_read_b64_tr_b16 v[126:127], v7 offset:15360
s_waitcnt lgkmcnt(9)
v_mfma_f32_32x32x16_bf16 v[16:31], v[112:115], v[80:83], v[16:31]
s_waitcnt lgkmcnt(6)
v_mfma_f32_32x32x16_bf16 v[16:31], v[116:119], v[84:87], v[16:31]
s_waitcnt lgkmcnt(3)
v_mfma_f32_32x32x16_bf16 v[16:31], v[120:123], v[88:91], v[16:31]
s_waitcnt lgkmcnt(0)
v_mfma_f32_32x32x16_bf16 v[16:31], v[124:127], v[92:95], v[16:31]
v_add_u32 v6, 0x2000, v6
v_add_u32 v7, 0x4000, v7
s_add_u32 s35, s35, 1
s_cmp_lt_u32 s35, 4
s_cbranch_scc1 L_k3_loop
s_cmp_eq_u32 s67, 0
s_cbranch_scc1 L_k3_fin
s_lshl_b32 s33, s32, 7
s_add_u32 s33, s33, 131072
v_lshl_add_u32 v14, v3, 5, s33
L_k3_ap:
s_ff1_i32_b32 s58, s67
s_bitset0_b32 s67, s58
s_mov_b32 m0, s58
s_lshl_b32 s34, s58, 8
s_movrels_b32 s59, s40
v_add_u32 v15, s34, v14
ds_read_b128 v[64:67], v15
ds_read_b128 v[68:71], v15 offset:16
ds_read_b128 v[72:75], v15 offset:64
ds_read_b128 v[76:79], v15 offset:80
s_and_b32 s59, s59, 31
v_cmp_eq_u32 vcc, s59, v2
s_waitcnt lgkmcnt(0)
s_and_saveexec_b64 s[64:65], vcc
v_add_f32 v40, v40, v64
v_add_f32 v41, v41, v65
v_add_f32 v42, v42, v66
v_add_f32 v43, v43, v67
v_add_f32 v44, v44, v68
v_add_f32 v45, v45, v69
v_add_f32 v46, v46, v70
v_add_f32 v47, v47, v71
v_add_f32 v48, v48, v72
v_add_f32 v49, v49, v73
v_add_f32 v50, v50, v74
v_add_f32 v51, v51, v75
v_add_f32 v52, v52, v76
v_add_f32 v53, v53, v77
v_add_f32 v54, v54, v78
v_add_f32 v55, v55, v79
s_mov_b64 exec, s[64:65]
s_cmp_lg_u32 s67, 0
s_cbranch_scc1 L_k3_ap
L_k3_fin:
s_nop 7
v_permlane32_swap_b32 v16, v20
v_permlane32_swap_b32 v24, v28
v_permlane32_swap_b32 v17, v21
v_permlane32_swap_b32 v25, v29
v_permlane32_swap_b32 v18, v22
v_permlane32_swap_b32 v26, v30
v_permlane32_swap_b32 v19, v23
v_permlane32_swap_b32 v27, v31
v_pk_add_f32 v[40:41], v[40:41], v[16:17]
v_pk_add_f32 v[42:43], v[42:43], v[18:19]
v_pk_add_f32 v[44:45], v[44:45], v[20:21]
v_pk_add_f32 v[46:47], v[46:47], v[22:23]
v_pk_add_f32 v[48:49], v[48:49], v[24:25]
v_pk_add_f32 v[50:51], v[50:51], v[26:27]
v_pk_add_f32 v[52:53], v[52:53], v[28:29]
v_pk_add_f32 v[54:55], v[54:55], v[30:31]
v_cvt_pk_bf16_f32 v32, v40, v41
v_cvt_pk_bf16_f32 v33, v42, v43
v_cvt_pk_bf16_f32 v34, v44, v45
v_cvt_pk_bf16_f32 v35, v46, v47
v_cvt_pk_bf16_f32 v36, v48, v49
v_cvt_pk_bf16_f32 v37, v50, v51
v_cvt_pk_bf16_f32 v38, v52, v53
v_cvt_pk_bf16_f32 v39, v54, v55
buffer_store_dwordx4 v[32:35], v8, s[20:23], 0 offen
buffer_store_dwordx4 v[36:39], v8, s[20:23], 0 offen offset:32
L_k3_end:
s_endpgm
L_code_end:
.section .rodata,"a"
.p2align 6
.amdhsa_kernel k1_kernel
  .amdhsa_next_free_vgpr 192
  .amdhsa_next_free_sgpr 102
  .amdhsa_accum_offset 192
  .amdhsa_group_segment_fixed_size 0
  .amdhsa_kernarg_size 88
  .amdhsa_user_sgpr_count 2
  .amdhsa_user_sgpr_kernarg_segment_ptr 1
  .amdhsa_system_sgpr_workgroup_id_x 1
  .amdhsa_float_denorm_mode_32 3
.end_amdhsa_kernel
.p2align 6
.amdhsa_kernel k2_kernel
  .amdhsa_next_free_vgpr 128
  .amdhsa_next_free_sgpr 102
  .amdhsa_accum_offset 128
  .amdhsa_group_segment_fixed_size 0
  .amdhsa_kernarg_size 88
  .amdhsa_user_sgpr_count 2
  .amdhsa_user_sgpr_kernarg_segment_ptr 1
  .amdhsa_system_sgpr_workgroup_id_x 1
  .amdhsa_float_denorm_mode_32 3
.end_amdhsa_kernel
.p2align 6
.amdhsa_kernel k3_kernel
  .amdhsa_next_free_vgpr 144
  .amdhsa_next_free_sgpr 102
  .amdhsa_accum_offset 144
  .amdhsa_group_segment_fixed_size 0
  .amdhsa_kernarg_size 88
  .amdhsa_user_sgpr_count 2
  .amdhsa_user_sgpr_kernarg_segment_ptr 1
  .amdhsa_system_sgpr_workgroup_id_x 1
  .amdhsa_float_denorm_mode_32 3
.end_amdhsa_kernel
```
